```python
import torch

def _softmax(x, axis=-1):
    return torch.softmax(x, dim=axis)
def _gelu(x):
    return torch.nn.functional.gelu(x, approximate="tanh")
def _silu(x):
    return torch.nn.functional.silu(x)
def _sigmoid(x):
    return torch.sigmoid(x)
def _layernorm(x, axis=-1, eps=1e-5):
    m = x.mean(dim=axis, keepdim=True)
    v = x.var(dim=axis, keepdim=True, unbiased=False)
    return (x - m) / torch.sqrt(v + eps)
def _scatter_add(tgt, idx, src, axis=0):
    return tgt.clone().index_add_(axis, idx, src)
def _segment_sum(src, seg, n):
    out = torch.zeros((n,) + src.shape[1:], dtype=src.dtype)
    return out.index_add_(0, seg, src)
def _pad(x, pw):
    flat = tuple(v for pair in reversed(pw) for v in pair)
    return torch.nn.functional.pad(x, flat)

kernel_name = 'standalone__deep_cross_wide_deep__recsys'

def setup_inputs():

    _w = (lambda a: (lambda t: t.to(torch.bfloat16) if t.is_floating_point() else t)(torch.as_tensor(a)))
    B, F, D = 4096, 26, 128
    V, Nd = min(1000, 100000), 13
    Din = F * D
    H = 4 * D
    return {
        "idx": _w((lambda lo, hi, *s: torch.randint(lo, hi, s))(0, V, B, F).to(torch.int64)),
        "table": _w((lambda *s: torch.randn(*s, dtype=torch.bfloat16) * 1.6)(V, D) * 0.05),
        "x_wide": _w((lambda *s: torch.randn(*s, dtype=torch.bfloat16) * 1.6)(B, Nd)),
        "w_wide": _w((lambda *s: torch.randn(*s, dtype=torch.bfloat16) * 1.6)(Nd) * 0.05),
        "b_wide": _w((lambda *s: torch.randn(*s, dtype=torch.bfloat16) * 1.6)(1) * 0.01),
        "W1": _w((lambda *s: torch.randn(*s, dtype=torch.bfloat16) * 1.6)(Din, H) * (2.0 / Din) ** 0.5),
        "b1": _w((lambda *s: torch.randn(*s, dtype=torch.bfloat16) * 1.6)(H) * 0.01),
        "W2": _w((lambda *s: torch.randn(*s, dtype=torch.bfloat16) * 1.6)(H) * (1.0 / H) ** 0.5),
        "b2": _w((lambda *s: torch.randn(*s, dtype=torch.bfloat16) * 1.6)(1) * 0.01),
    }

def reference(idx, table, x_wide, w_wide, b_wide, W1, b1, W2, b2):
    emb = table[idx]
    deep_in = emb.reshape(emb.shape[0], -1)
    h = deep_in @ W1 + b1
    h = h * (lambda x, dt: x.to(dt))(h > 0, h.dtype)
    deep_logit = h @ W2 + b2
    wide_logit = x_wide @ w_wide + b_wide
    return _sigmoid(wide_logit + deep_logit)
```

```asm
; @launch grid=(256,1,1) block=(256,1,1) lds=163840
.amdgcn_target "amdgcn-amd-amdhsa--gfx950"
.text
.globl standalone__deep_cross_wide_deep__recsys_kernel
.p2align 8
.type standalone__deep_cross_wide_deep__recsys_kernel,@function
standalone__deep_cross_wide_deep__recsys_kernel:
    s_cmp_ge_u32 s2, 256
    s_cbranch_scc1 L_end
    s_load_dwordx16 s[4:19], s[0:1], 0
    s_load_dwordx8 s[20:27], s[0:1], 64
    v_lshrrev_b32 v10, 6, v0
    v_and_b32 v1, 63, v0
    v_readfirstlane_b32 s64, v10
    s_and_b32 s65, s2, 7
    s_lshr_b32 s66, s2, 3
    v_and_b32 v4, 31, v0
    s_mov_b32 s68, 34816
    s_mov_b32 s69, 0x05040100
    s_mov_b32 s70, 0x07060302
    s_mov_b32 s90, 0xffff0000
    s_lshl_b32 s67, s64, 2
    s_lshl_b32 s85, s64, 10
    s_lshl_b32 s86, s64, 12
    s_min_u32 s81, s64, 2
    s_lshl_b32 s87, s81, 10
    s_lshl_b32 s88, s81, 12
    s_mul_i32 s81, s66, 13312
    s_add_u32 s81, s81, s86
    v_lshlrev_b32 v11, 4, v1
    v_add_u32 v11, s81, v11
    s_lshl_b32 s82, s66, 3
    s_add_u32 s82, s82, s65
    s_lshl_b32 s82, s82, 9
    s_lshl_b32 s83, s64, 7
    s_add_u32 s82, s82, s83
    v_lshlrev_b32 v5, 2, v4
    v_add_u32 v5, s82, v5
    v_mov_b32 v250, -1
    v_lshrrev_b32 v13, 4, v1
    v_sub_u32 v13, v1, v13
    v_and_b32 v13, 3, v13
    v_lshlrev_b32 v13, 4, v13
    v_lshrrev_b32 v14, 2, v1
    v_lshl_add_u32 v3, v14, 8, v13
    v_add_u32 v254, 64, v3
    v_lshrrev_b32 v13, 5, v1
    s_mov_b32 s83, 1703936
    v_mul_lo_u32 v13, v13, s83
    v_bfe_u32 v14, v1, 3, 2
    v_lshl_add_u32 v13, v14, 11, v13
    v_and_b32 v14, 7, v1
    v_lshl_add_u32 v13, v14, 4, v13
    v_and_b32 v14, 15, v1
    s_mov_b32 vcc_lo, 0x00ff00ff
    s_mov_b32 vcc_hi, 0x00ff00ff
    s_lshl_b32 s83, s64, 13
    s_lshl_b32 s84, s65, 7
    s_add_u32 s83, s83, s84
    v_add_u32 v2, s83, v13
    s_lshl_b32 s83, s66, 2
    s_add_u32 s83, s83, s64
    s_mul_i32 s81, s83, 26
    v_min_u32 v13, 25, v1
    v_add_u32 v13, s81, v13
    v_lshlrev_b32 v13, 10, v13
    v_add_u32 v252, s84, v13
    s_lshl_b32 s81, s83, 11
    v_lshlrev_b32 v14, 7, v14
    v_add_u32 v253, s81, v14
    v_and_b32 v13, 7, v1
    s_lshl_b32 s81, s83, 3
    v_add_u32 v13, s81, v13
    v_lshlrev_b32 v253, 8, v13
    v_lshrrev_b32 v14, 5, v13
    v_and_b32 v13, 31, v13
    v_lshlrev_b32 v14, 17, v14
    v_lshl_add_u32 v13, v13, 10, v14
    v_add_u32 v252, s84, v13
    v_lshrrev_b32 v14, 3, v1
    v_min_u32 v13, 1, v14
    v_add_u32 v13, 2, v13
    v_lshl_add_u32 v180, v13, 15, v252
    v_min_u32 v14, 1, v14
    v_lshl_add_u32 v252, v14, 15, v252
    s_add_u32 m0, s86, 0
    s_mov_b32 s30, 425984
    s_mov_b32 s31, 0x00020000
    s_mov_b32 s62, 1048576
    s_mov_b32 s63, 0x00020000
    s_mov_b32 s34, 256000
    s_mov_b32 s35, 0x00020000
    s_mov_b32 s38, 3407872
    s_mov_b32 s39, 0x00020000
    s_mov_b32 s42, 106496
    s_mov_b32 s43, 0x00020000
    s_mov_b32 s46, 1024
    s_mov_b32 s47, 0x00020000
    s_mov_b32 s50, 1024
    s_mov_b32 s51, 0x00020000
    s_mov_b32 s54, 8192
    s_mov_b32 s55, 0x00020000
    s_mov_b32 s58, 256
    s_mov_b32 s59, 0x00020000
    s_and_b32 s91, s83, 63
    s_waitcnt lgkmcnt(0)
    s_mov_b64 s[28:29], s[4:5]
    s_mov_b64 s[32:33], s[6:7]
    buffer_load_dwordx4 v11, s[28:31], 0 offen offset:0 lds
    buffer_load_dwordx4 v11, s[28:31], 0 offen offset:1024 lds
    buffer_load_dwordx4 v11, s[28:31], 0 offen offset:2048 lds
    buffer_load_dwordx4 v11, s[28:31], 0 offen offset:3072 lds
    s_mov_b64 s[36:37], s[14:15]
    s_mov_b64 s[60:61], s[26:27]
    s_min_u32 s82, s91, 62
    s_lshl_b32 s83, s82, 10
    s_add_u32 m0, s83, 99328
    s_lshl_b32 s89, s82, 12
    buffer_load_dwordx4 v3, s[32:35], s89 offen lds
    s_add_u32 m0, s83, 34816
    s_nop 0
    buffer_load_dwordx4 v254, s[32:35], s89 offen lds
    s_mov_b32 s71, 0
    buffer_load_dwordx4 v[88:91], v2, s[36:39], s71 offen offset:0
    buffer_load_dwordx4 v[92:95], v2, s[36:39], s71 offen offset:1024
    buffer_load_dword v255, v252, s[36:39], 0 offen
    buffer_store_dword v250, v5, s[60:63], 0 offen sc1
    s_load_dwordx4 s[72:75], s[10:11], 0
    s_load_dwordx2 s[76:77], s[10:11], 16
    s_load_dword s78, s[10:11], 24
    s_load_dword s79, s[12:13], 0
    s_load_dword s80, s[20:21], 0
    s_add_u32 s91, s91, 4
    s_and_b32 s91, s91, 63
    s_min_u32 s82, s91, 62
    s_lshl_b32 s83, s82, 10
    s_add_u32 m0, s83, 99328
    s_lshl_b32 s89, s82, 12
    buffer_load_dwordx4 v3, s[32:35], s89 offen lds
    s_add_u32 m0, s83, 34816
    s_nop 0
    buffer_load_dwordx4 v254, s[32:35], s89 offen lds
    s_mov_b64 s[40:41], s[8:9]
    s_mov_b64 s[44:45], s[16:17]
    s_mov_b64 s[48:49], s[18:19]
    s_mov_b64 s[52:53], s[22:23]
    s_mov_b64 s[56:57], s[24:25]
    v_lshrrev_b32 v13, 5, v1
    v_lshl_add_u32 v13, v4, 1, v13
    v_mul_u32_u24 v13, 52, v13
    v_lshlrev_b32 v14, 4, v1
    s_add_u32 s82, s64, 1
    s_and_b32 s82, s82, 3
    s_mul_i32 s81, s82, 3328
    s_mul_i32 s84, s82, 24576
    s_add_u32 s84, s84, 64512
    v_add_u32 v6, s84, v14
    v_add_u32 v10, s81, v13
    s_add_u32 s82, s64, 2
    s_and_b32 s82, s82, 3
    s_mul_i32 s81, s82, 3328
    s_mul_i32 s84, s82, 24576
    s_add_u32 s84, s84, 72704
    v_add_u32 v8, s84, v14
    v_add_u32 v11, s81, v13
    s_add_u32 s82, s64, 3
    s_and_b32 s82, s82, 3
    s_mul_i32 s81, s82, 3328
    s_mul_i32 s84, s82, 24576
    s_add_u32 s84, s84, 80896
    v_add_u32 v9, s84, v14
    v_add_u32 v12, s81, v13
    s_add_u32 s82, s64, 4
    s_and_b32 s82, s82, 3
    s_mul_i32 s81, s82, 3328
    s_mul_i32 s84, s82, 24576
    s_add_u32 s84, s84, 64512
    v_add_u32 v7, s84, v14
    v_add_u32 v13, s81, v13
    s_waitcnt lgkmcnt(0)
    s_waitcnt vmcnt(8)
    s_barrier
    buffer_load_dword v255, v180, s[36:39], 0 offen
    s_add_u32 s91, s91, 4
    s_and_b32 s91, s91, 63
    s_min_u32 s82, s91, 62
    s_lshl_b32 s83, s82, 10
    s_add_u32 m0, s83, 99328
    s_lshl_b32 s89, s82, 12
    buffer_load_dwordx4 v3, s[32:35], s89 offen lds
    s_add_u32 m0, s83, 34816
    s_nop 0
    buffer_load_dwordx4 v254, s[32:35], s89 offen lds
    ds_read2_b32 v[16:17], v10 offset0:0 offset1:1
    ds_read2_b32 v[30:31], v11 offset0:0 offset1:1
    ds_read2_b32 v[44:45], v12 offset0:0 offset1:1
    ds_read2_b32 v[58:59], v13 offset0:0 offset1:1
    ds_read2_b32 v[18:19], v10 offset0:2 offset1:3
    ds_read2_b32 v[32:33], v11 offset0:2 offset1:3
    ds_read2_b32 v[46:47], v12 offset0:2 offset1:3
    ds_read2_b32 v[60:61], v13 offset0:2 offset1:3
    ds_read2_b32 v[20:21], v10 offset0:4 offset1:5
    ds_read2_b32 v[34:35], v11 offset0:4 offset1:5
    ds_read2_b32 v[48:49], v12 offset0:4 offset1:5
    ds_read2_b32 v[62:63], v13 offset0:4 offset1:5
    ds_read2_b32 v[22:23], v10 offset0:6 offset1:7
    ds_read2_b32 v[36:37], v11 offset0:6 offset1:7
    ds_read2_b32 v[50:51], v12 offset0:6 offset1:7
    ds_read2_b32 v[64:65], v13 offset0:6 offset1:7
    s_add_u32 s91, s91, 4
    s_and_b32 s91, s91, 63
    s_min_u32 s82, s91, 62
    s_lshl_b32 s83, s82, 10
    s_add_u32 m0, s83, 99328
    s_lshl_b32 s89, s82, 12
    buffer_load_dwordx4 v3, s[32:35], s89 offen lds
    s_add_u32 m0, s83, 34816
    s_nop 0
    buffer_load_dwordx4 v254, s[32:35], s89 offen lds
    ds_read2_b32 v[24:25], v10 offset0:8 offset1:9
    ds_read2_b32 v[38:39], v11 offset0:8 offset1:9
    ds_read2_b32 v[52:53], v12 offset0:8 offset1:9
    ds_read2_b32 v[66:67], v13 offset0:8 offset1:9
    ds_read2_b32 v[26:27], v10 offset0:10 offset1:11
    ds_read2_b32 v[40:41], v11 offset0:10 offset1:11
    ds_read2_b32 v[54:55], v12 offset0:10 offset1:11
    ds_read2_b32 v[68:69], v13 offset0:10 offset1:11
    ds_read2_b32 v[28:29], v10 offset0:12 offset1:13
    ds_read2_b32 v[42:43], v11 offset0:12 offset1:13
    ds_read2_b32 v[56:57], v12 offset0:12 offset1:13
    ds_read2_b32 v[70:71], v13 offset0:12 offset1:13
    s_waitcnt lgkmcnt(15)
    v_add_lshl_u32 v14, v16, s67, 2
    v_and_or_b32 v14, v14, 48, s68
    v_lshl_add_u32 v16, v16, 6, v14
    v_add_lshl_u32 v15, v17, s67, 2
    s_add_u32 s91, s91, 4
    s_and_b32 s91, s91, 63
    s_min_u32 s82, s91, 62
    s_lshl_b32 s83, s82, 10
    s_add_u32 m0, s83, 99328
    s_lshl_b32 s89, s82, 12
    buffer_load_dwordx4 v3, s[32:35], s89 offen lds
    s_add_u32 m0, s83, 34816
    s_nop 0
    buffer_load_dwordx4 v254, s[32:35], s89 offen lds
    v_and_or_b32 v15, v15, 48, s68
    v_lshl_add_u32 v17, v17, 6, v15
    v_add_lshl_u32 v14, v30, s67, 2
    v_and_or_b32 v14, v14, 48, s68
    v_lshl_add_u32 v30, v30, 6, v14
    v_add_lshl_u32 v15, v31, s67, 2
    v_and_or_b32 v15, v15, 48, s68
    v_lshl_add_u32 v31, v31, 6, v15
    v_add_lshl_u32 v14, v44, s67, 2
    v_and_or_b32 v14, v14, 48, s68
    v_lshl_add_u32 v44, v44, 6, v14
    v_add_lshl_u32 v15, v45, s67, 2
    v_and_or_b32 v15, v15, 48, s68
    v_lshl_add_u32 v45, v45, 6, v15
    s_add_u32 s91, s91, 4
    s_and_b32 s91, s91, 63
    s_min_u32 s82, s91, 62
    s_lshl_b32 s83, s82, 10
    s_add_u32 m0, s83, 99328
    s_lshl_b32 s89, s82, 12
    buffer_load_dwordx4 v3, s[32:35], s89 offen lds
    s_add_u32 m0, s83, 34816
    s_nop 0
    buffer_load_dwordx4 v254, s[32:35], s89 offen lds
    v_add_lshl_u32 v14, v58, s67, 2
    v_and_or_b32 v14, v14, 48, s68
    v_lshl_add_u32 v58, v58, 6, v14
    v_add_lshl_u32 v15, v59, s67, 2
    v_and_or_b32 v15, v15, 48, s68
    v_lshl_add_u32 v59, v59, 6, v15
    v_add_lshl_u32 v14, v18, s67, 2
    v_and_or_b32 v14, v14, 48, s68
    v_lshl_add_u32 v18, v18, 6, v14
    v_add_lshl_u32 v15, v19, s67, 2
    v_and_or_b32 v15, v15, 48, s68
    v_lshl_add_u32 v19, v19, 6, v15
    v_add_lshl_u32 v14, v32, s67, 2
    v_and_or_b32 v14, v14, 48, s68
    s_add_u32 s91, s91, 4
    s_and_b32 s91, s91, 63
    s_min_u32 s82, s91, 62
    s_lshl_b32 s83, s82, 10
    s_add_u32 m0, s83, 99328
    s_lshl_b32 s89, s82, 12
    buffer_load_dwordx4 v3, s[32:35], s89 offen lds
    s_add_u32 m0, s83, 34816
    s_nop 0
    buffer_load_dwordx4 v254, s[32:35], s89 offen lds
    v_lshl_add_u32 v32, v32, 6, v14
    v_add_lshl_u32 v15, v33, s67, 2
    v_and_or_b32 v15, v15, 48, s68
    v_lshl_add_u32 v33, v33, 6, v15
    v_add_lshl_u32 v14, v46, s67, 2
    v_and_or_b32 v14, v14, 48, s68
    v_lshl_add_u32 v46, v46, 6, v14
    v_add_lshl_u32 v15, v47, s67, 2
    v_and_or_b32 v15, v15, 48, s68
    v_lshl_add_u32 v47, v47, 6, v15
    v_add_lshl_u32 v14, v60, s67, 2
    v_and_or_b32 v14, v14, 48, s68
    v_lshl_add_u32 v60, v60, 6, v14
    v_add_lshl_u32 v15, v61, s67, 2
    v_and_or_b32 v15, v15, 48, s68
    s_add_u32 s91, s91, 4
    s_and_b32 s91, s91, 63
    s_min_u32 s82, s91, 62
    s_lshl_b32 s83, s82, 10
    s_add_u32 m0, s83, 99328
    s_lshl_b32 s89, s82, 12
    buffer_load_dwordx4 v3, s[32:35], s89 offen lds
    s_add_u32 m0, s83, 34816
    s_nop 0
    buffer_load_dwordx4 v254, s[32:35], s89 offen lds
    v_lshl_add_u32 v61, v61, 6, v15
    v_add_lshl_u32 v14, v20, s67, 2
    v_and_or_b32 v14, v14, 48, s68
    v_lshl_add_u32 v20, v20, 6, v14
    v_add_lshl_u32 v15, v21, s67, 2
    v_and_or_b32 v15, v15, 48, s68
    v_lshl_add_u32 v21, v21, 6, v15
    v_add_lshl_u32 v14, v34, s67, 2
    v_and_or_b32 v14, v14, 48, s68
    v_lshl_add_u32 v34, v34, 6, v14
    v_add_lshl_u32 v15, v35, s67, 2
    v_and_or_b32 v15, v15, 48, s68
    v_lshl_add_u32 v35, v35, 6, v15
    s_add_u32 s91, s91, 4
    s_and_b32 s91, s91, 63
    s_min_u32 s82, s91, 62
    s_lshl_b32 s83, s82, 10
    s_add_u32 m0, s83, 99328
    s_lshl_b32 s89, s82, 12
    buffer_load_dwordx4 v3, s[32:35], s89 offen lds
    s_add_u32 m0, s83, 34816
    s_nop 0
    buffer_load_dwordx4 v254, s[32:35], s89 offen lds
    v_add_lshl_u32 v14, v48, s67, 2
    v_and_or_b32 v14, v14, 48, s68
    v_lshl_add_u32 v48, v48, 6, v14
    v_add_lshl_u32 v15, v49, s67, 2
    v_and_or_b32 v15, v15, 48, s68
    v_lshl_add_u32 v49, v49, 6, v15
    v_add_lshl_u32 v14, v62, s67, 2
    v_and_or_b32 v14, v14, 48, s68
    v_lshl_add_u32 v62, v62, 6, v14
    v_add_lshl_u32 v15, v63, s67, 2
    v_and_or_b32 v15, v15, 48, s68
    v_lshl_add_u32 v63, v63, 6, v15
    v_add_lshl_u32 v14, v22, s67, 2
    v_and_or_b32 v14, v14, 48, s68
    v_lshl_add_u32 v22, v22, 6, v14
    s_add_u32 s91, s91, 4
    s_and_b32 s91, s91, 63
    s_min_u32 s82, s91, 62
    s_lshl_b32 s83, s82, 10
    s_add_u32 m0, s83, 99328
    s_lshl_b32 s89, s82, 12
    buffer_load_dwordx4 v3, s[32:35], s89 offen lds
    s_add_u32 m0, s83, 34816
    s_nop 0
    buffer_load_dwordx4 v254, s[32:35], s89 offen lds
    v_add_lshl_u32 v15, v23, s67, 2
    v_and_or_b32 v15, v15, 48, s68
    v_lshl_add_u32 v23, v23, 6, v15
    s_waitcnt lgkmcnt(14)
    v_add_lshl_u32 v14, v36, s67, 2
    v_and_or_b32 v14, v14, 48, s68
    v_lshl_add_u32 v36, v36, 6, v14
    v_add_lshl_u32 v15, v37, s67, 2
    v_and_or_b32 v15, v15, 48, s68
    v_lshl_add_u32 v37, v37, 6, v15
    s_waitcnt lgkmcnt(13)
    v_add_lshl_u32 v14, v50, s67, 2
    v_and_or_b32 v14, v14, 48, s68
    v_lshl_add_u32 v50, v50, 6, v14
    v_add_lshl_u32 v15, v51, s67, 2
    v_and_or_b32 v15, v15, 48, s68
    v_lshl_add_u32 v51, v51, 6, v15
    s_add_u32 s91, s91, 4
    s_and_b32 s91, s91, 63
    s_min_u32 s82, s91, 62
    s_lshl_b32 s83, s82, 10
    s_add_u32 m0, s83, 99328
    s_lshl_b32 s89, s82, 12
    buffer_load_dwordx4 v3, s[32:35], s89 offen lds
    s_add_u32 m0, s83, 34816
    s_nop 0
    buffer_load_dwordx4 v254, s[32:35], s89 offen lds
    s_waitcnt lgkmcnt(12)
    v_add_lshl_u32 v14, v64, s67, 2
    v_and_or_b32 v14, v14, 48, s68
    v_lshl_add_u32 v64, v64, 6, v14
    v_add_lshl_u32 v15, v65, s67, 2
    v_and_or_b32 v15, v15, 48, s68
    v_lshl_add_u32 v65, v65, 6, v15
    s_waitcnt lgkmcnt(11)
    v_add_lshl_u32 v14, v24, s67, 2
    v_and_or_b32 v14, v14, 48, s68
    v_lshl_add_u32 v24, v24, 6, v14
    v_add_lshl_u32 v15, v25, s67, 2
    v_and_or_b32 v15, v15, 48, s68
    v_lshl_add_u32 v25, v25, 6, v15
    s_waitcnt lgkmcnt(10)
    v_add_lshl_u32 v14, v38, s67, 2
    s_add_u32 s91, s91, 4
    s_and_b32 s91, s91, 63
    s_min_u32 s82, s91, 62
    s_lshl_b32 s83, s82, 10
    s_add_u32 m0, s83, 99328
    s_lshl_b32 s89, s82, 12
    buffer_load_dwordx4 v3, s[32:35], s89 offen lds
    s_add_u32 m0, s83, 34816
    s_nop 0
    buffer_load_dwordx4 v254, s[32:35], s89 offen lds
    v_and_or_b32 v14, v14, 48, s68
    v_lshl_add_u32 v38, v38, 6, v14
    v_add_lshl_u32 v15, v39, s67, 2
    v_and_or_b32 v15, v15, 48, s68
    v_lshl_add_u32 v39, v39, 6, v15
    s_waitcnt lgkmcnt(9)
    v_add_lshl_u32 v14, v52, s67, 2
    v_and_or_b32 v14, v14, 48, s68
    v_lshl_add_u32 v52, v52, 6, v14
    v_add_lshl_u32 v15, v53, s67, 2
    v_and_or_b32 v15, v15, 48, s68
    v_lshl_add_u32 v53, v53, 6, v15
    s_waitcnt lgkmcnt(8)
    v_add_lshl_u32 v14, v66, s67, 2
    v_and_or_b32 v14, v14, 48, s68
    v_lshl_add_u32 v66, v66, 6, v14
    v_add_lshl_u32 v15, v67, s67, 2
    s_add_u32 s91, s91, 4
    s_and_b32 s91, s91, 63
    s_min_u32 s82, s91, 62
    s_lshl_b32 s83, s82, 10
    s_add_u32 m0, s83, 99328
    s_lshl_b32 s89, s82, 12
    buffer_load_dwordx4 v3, s[32:35], s89 offen lds
    s_add_u32 m0, s83, 34816
    s_nop 0
    buffer_load_dwordx4 v254, s[32:35], s89 offen lds
    v_and_or_b32 v15, v15, 48, s68
    v_lshl_add_u32 v67, v67, 6, v15
    s_waitcnt lgkmcnt(7)
    v_add_lshl_u32 v14, v26, s67, 2
    v_and_or_b32 v14, v14, 48, s68
    v_lshl_add_u32 v26, v26, 6, v14
    v_add_lshl_u32 v15, v27, s67, 2
    v_and_or_b32 v15, v15, 48, s68
    v_lshl_add_u32 v27, v27, 6, v15
    s_waitcnt lgkmcnt(6)
    v_add_lshl_u32 v14, v40, s67, 2
    v_and_or_b32 v14, v14, 48, s68
    v_lshl_add_u32 v40, v40, 6, v14
    v_add_lshl_u32 v15, v41, s67, 2
    v_and_or_b32 v15, v15, 48, s68
    v_lshl_add_u32 v41, v41, 6, v15
    s_waitcnt lgkmcnt(5)
    s_add_u32 s91, s91, 4
    s_and_b32 s91, s91, 63
    s_min_u32 s82, s91, 62
    s_lshl_b32 s83, s82, 10
    s_add_u32 m0, s83, 99328
    s_lshl_b32 s89, s82, 12
    buffer_load_dwordx4 v3, s[32:35], s89 offen lds
    s_add_u32 m0, s83, 34816
    s_nop 0
    buffer_load_dwordx4 v254, s[32:35], s89 offen lds
    v_add_lshl_u32 v14, v54, s67, 2
    v_and_or_b32 v14, v14, 48, s68
    v_lshl_add_u32 v54, v54, 6, v14
    v_add_lshl_u32 v15, v55, s67, 2
    v_and_or_b32 v15, v15, 48, s68
    v_lshl_add_u32 v55, v55, 6, v15
    s_waitcnt lgkmcnt(4)
    v_add_lshl_u32 v14, v68, s67, 2
    v_and_or_b32 v14, v14, 48, s68
    v_lshl_add_u32 v68, v68, 6, v14
    v_add_lshl_u32 v15, v69, s67, 2
    v_and_or_b32 v15, v15, 48, s68
    v_lshl_add_u32 v69, v69, 6, v15
    s_waitcnt lgkmcnt(3)
    v_add_lshl_u32 v14, v28, s67, 2
    v_and_or_b32 v14, v14, 48, s68
    s_add_u32 s91, s91, 4
    s_and_b32 s91, s91, 63
    s_min_u32 s82, s91, 62
    s_lshl_b32 s83, s82, 10
    s_add_u32 m0, s83, 99328
    s_lshl_b32 s89, s82, 12
    buffer_load_dwordx4 v3, s[32:35], s89 offen lds
    s_add_u32 m0, s83, 34816
    s_nop 0
    buffer_load_dwordx4 v254, s[32:35], s89 offen lds
    v_lshl_add_u32 v28, v28, 6, v14
    s_waitcnt lgkmcnt(2)
    v_add_lshl_u32 v14, v42, s67, 2
    v_and_or_b32 v14, v14, 48, s68
    v_lshl_add_u32 v42, v42, 6, v14
    s_waitcnt lgkmcnt(1)
    v_add_lshl_u32 v14, v56, s67, 2
    v_and_or_b32 v14, v14, 48, s68
    v_lshl_add_u32 v56, v56, 6, v14
    s_waitcnt lgkmcnt(0)
    v_add_lshl_u32 v14, v70, s67, 2
    v_and_or_b32 v14, v14, 48, s68
    v_lshl_add_u32 v70, v70, 6, v14
    s_waitcnt vmcnt(31)
    v_cndmask_b32_dpp v248, v89, v88, vcc row_ror:8 row_mask:0xf bank_mask:0xf
    v_mov_b32_dpp v89, v88 row_ror:8 row_mask:0xf bank_mask:0x3
    v_cndmask_b32_dpp v249, v91, v90, vcc row_ror:8 row_mask:0xf bank_mask:0xf
    s_add_u32 s91, s91, 4
    s_and_b32 s91, s91, 63
    s_min_u32 s82, s91, 62
    s_lshl_b32 s83, s82, 10
    s_add_u32 m0, s83, 99328
    s_lshl_b32 s89, s82, 12
    buffer_load_dwordx4 v3, s[32:35], s89 offen lds
    s_add_u32 m0, s83, 34816
    s_nop 0
    buffer_load_dwordx4 v254, s[32:35], s89 offen lds
    v_mov_b32_dpp v91, v90 row_ror:8 row_mask:0xf bank_mask:0x3
    v_cndmask_b32_dpp v250, v93, v92, vcc row_ror:8 row_mask:0xf bank_mask:0xf
    v_mov_b32_dpp v93, v92 row_ror:8 row_mask:0xf bank_mask:0x3
    v_cndmask_b32_dpp v251, v95, v94, vcc row_ror:8 row_mask:0xf bank_mask:0xf
    v_mov_b32_dpp v95, v94 row_ror:8 row_mask:0xf bank_mask:0x3
    v_permlane16_swap_b32 v248, v249
    v_permlane16_swap_b32 v89, v91
    v_permlane16_swap_b32 v250, v251
    v_permlane16_swap_b32 v93, v95
    v_perm_b32 v72, v250, v248, s69
    v_perm_b32 v74, v251, v249, s69
    v_perm_b32 v73, v93, v89, s69
    v_perm_b32 v75, v95, v91, s69
    v_perm_b32 v76, v250, v248, s70
    v_perm_b32 v78, v251, v249, s70
    v_perm_b32 v77, v93, v89, s70
    v_perm_b32 v79, v95, v91, s70
    buffer_load_dword v255, v253, s[32:35], 0 offen offset:128
    s_mov_b32 s71, 131072
    buffer_load_dwordx4 v[96:99], v2, s[36:39], s71 offen offset:0
    buffer_load_dwordx4 v[100:103], v2, s[36:39], s71 offen offset:1024
    s_mov_b32 s71, 262144
    buffer_load_dwordx4 v[104:107], v2, s[36:39], s71 offen offset:0
    buffer_load_dwordx4 v[108:111], v2, s[36:39], s71 offen offset:1024
    s_mov_b32 s71, 393216
    buffer_load_dwordx4 v[112:115], v2, s[36:39], s71 offen offset:0
    buffer_load_dwordx4 v[116:119], v2, s[36:39], s71 offen offset:1024
    s_mov_b32 s71, 524288
    buffer_load_dwordx4 v[120:123], v2, s[36:39], s71 offen offset:0
    buffer_load_dwordx4 v[124:127], v2, s[36:39], s71 offen offset:1024
    s_waitcnt vmcnt(9)
    s_barrier
    ds_read_b128 a[128:131], v16 offset:64512
    ds_read_b128 a[132:135], v30 offset:64512
    ds_read_b128 a[136:139], v44 offset:64512
    ds_read_b128 a[140:143], v58 offset:64512
    ds_read_b128 a[144:147], v17 offset:64512
    ds_read_b128 a[148:151], v31 offset:64512
    ds_read_b128 a[152:155], v45 offset:64512
    ds_read_b128 a[156:159], v59 offset:64512
    s_lshl_b32 s82, s66, 3
    v_mov_b32 v11, s82
    s_cmp_lg_u32 s64, 0
    s_cbranch_scc1 L_nosig
    v_mov_b32 v15, 1
    s_mov_b64 exec, 1
    buffer_atomic_add v15, v11, s[56:59], 0 offen sc1
    s_mov_b64 exec, -1
L_nosig:
    s_waitcnt vmcnt(6) lgkmcnt(7)
    v_mfma_f32_32x32x16_bf16 a[0:15], v[72:75], a[128:131], 0
    v_cndmask_b32_dpp v248, v97, v96, vcc row_ror:8 row_mask:0xf bank_mask:0xf
    s_mov_b32 s71, 655360
    v_mov_b32_dpp v97, v96 row_ror:8 row_mask:0xf bank_mask:0x3
    v_cndmask_b32_dpp v249, v99, v98, vcc row_ror:8 row_mask:0xf bank_mask:0xf
    v_mov_b32_dpp v99, v98 row_ror:8 row_mask:0xf bank_mask:0x3
    v_mfma_f32_32x32x16_bf16 a[16:31], v[76:79], a[128:131], 0
    ds_read_b128 a[160:163], v18 offset:64512
    buffer_load_dwordx4 v[128:131], v2, s[36:39], s71 offen offset:0
    v_cndmask_b32_dpp v250, v101, v100, vcc row_ror:8 row_mask:0xf bank_mask:0xf
    v_mov_b32_dpp v101, v100 row_ror:8 row_mask:0xf bank_mask:0x3
    s_waitcnt lgkmcnt(7)
    v_mfma_f32_32x32x16_bf16 a[32:47], v[72:75], a[132:135], 0
    v_cndmask_b32_dpp v251, v103, v102, vcc row_ror:8 row_mask:0xf bank_mask:0xf
    v_mov_b32_dpp v103, v102 row_ror:8 row_mask:0xf bank_mask:0x3
    v_permlane16_swap_b32 v248, v249
    v_mfma_f32_32x32x16_bf16 a[48:63], v[76:79], a[132:135], 0
    ds_read_b128 a[164:167], v32 offset:64512
    v_permlane16_swap_b32 v97, v99
    buffer_load_dwordx4 v[132:135], v2, s[36:39], s71 offen offset:1024
    s_waitcnt lgkmcnt(7)
    v_mfma_f32_32x32x16_bf16 a[64:79], v[72:75], a[136:139], 0
    v_permlane16_swap_b32 v250, v251
    v_permlane16_swap_b32 v101, v103
    v_perm_b32 v80, v250, v248, s69
    v_mfma_f32_32x32x16_bf16 a[80:95], v[76:79], a[136:139], 0
    ds_read_b128 a[168:171], v46 offset:64512
    s_mov_b32 s71, 786432
    v_perm_b32 v82, v251, v249, s69
    v_perm_b32 v81, v101, v97, s69
    v_perm_b32 v83, v103, v99, s69
    s_waitcnt lgkmcnt(7)
    v_mfma_f32_32x32x16_bf16 a[96:111], v[72:75], a[140:143], 0
    v_perm_b32 v84, v250, v248, s70
    buffer_load_dwordx4 v[136:139], v2, s[36:39], s71 offen offset:0
    v_perm_b32 v86, v251, v249, s70
    v_perm_b32 v85, v101, v97, s70
    v_mfma_f32_32x32x16_bf16 a[112:127], v[76:79], a[140:143], 0
    ds_read_b128 a[172:175], v60 offset:64512
    v_perm_b32 v87, v103, v99, s70
    s_nop 0
    s_waitcnt vmcnt(7) lgkmcnt(4)
    v_mfma_f32_32x32x16_bf16 a[0:15], v[80:83], a[144:147], a[0:15]
    v_cndmask_b32_dpp v248, v105, v104, vcc row_ror:8 row_mask:0xf bank_mask:0xf
    buffer_load_dwordx4 v[140:143], v2, s[36:39], s71 offen offset:1024
    v_mov_b32_dpp v105, v104 row_ror:8 row_mask:0xf bank_mask:0x3
    v_cndmask_b32_dpp v249, v107, v106, vcc row_ror:8 row_mask:0xf bank_mask:0xf
    v_mfma_f32_32x32x16_bf16 a[16:31], v[84:87], a[144:147], a[16:31]
    ds_read_b128 a[176:179], v19 offset:64512
    v_mov_b32_dpp v107, v106 row_ror:8 row_mask:0xf bank_mask:0x3
    v_cndmask_b32_dpp v250, v109, v108, vcc row_ror:8 row_mask:0xf bank_mask:0xf
    v_mov_b32_dpp v109, v108 row_ror:8 row_mask:0xf bank_mask:0x3
    v_cndmask_b32_dpp v251, v111, v110, vcc row_ror:8 row_mask:0xf bank_mask:0xf
    v_mfma_f32_32x32x16_bf16 a[32:47], v[80:83], a[148:151], a[32:47]
    v_mov_b32_dpp v111, v110 row_ror:8 row_mask:0xf bank_mask:0x3
    s_mov_b32 s71, 917504
    v_permlane16_swap_b32 v248, v249
    v_mfma_f32_32x32x16_bf16 a[48:63], v[84:87], a[148:151], a[48:63]
    ds_read_b128 a[180:183], v33 offset:64512
    v_permlane16_swap_b32 v105, v107
    buffer_load_dwordx4 v[144:147], v2, s[36:39], s71 offen offset:0
    v_mfma_f32_32x32x16_bf16 a[64:79], v[80:83], a[152:155], a[64:79]
    v_permlane16_swap_b32 v250, v251
    v_permlane16_swap_b32 v109, v111
    v_perm_b32 v72, v250, v248, s69
    v_mfma_f32_32x32x16_bf16 a[80:95], v[84:87], a[152:155], a[80:95]
    ds_read_b128 a[184:187], v47 offset:64512
    v_perm_b32 v74, v251, v249, s69
    v_perm_b32 v73, v109, v105, s69
    v_perm_b32 v75, v111, v107, s69
    v_mfma_f32_32x32x16_bf16 a[96:111], v[80:83], a[156:159], a[96:111]
    buffer_load_dwordx4 v[148:151], v2, s[36:39], s71 offen offset:1024
    v_perm_b32 v76, v250, v248, s70
    v_perm_b32 v78, v251, v249, s70
    v_perm_b32 v77, v109, v105, s70
    v_mfma_f32_32x32x16_bf16 a[112:127], v[84:87], a[156:159], a[112:127]
    ds_read_b128 a[188:191], v61 offset:64512
    v_perm_b32 v79, v111, v107, s70
    s_nop 0
    s_waitcnt vmcnt(8) lgkmcnt(4)
    v_mfma_f32_32x32x16_bf16 a[0:15], v[72:75], a[160:163], a[0:15]
    v_cndmask_b32_dpp v248, v113, v112, vcc row_ror:8 row_mask:0xf bank_mask:0xf
    s_mov_b32 s71, 1048576
    v_mov_b32_dpp v113, v112 row_ror:8 row_mask:0xf bank_mask:0x3
    v_cndmask_b32_dpp v249, v115, v114, vcc row_ror:8 row_mask:0xf bank_mask:0xf
    v_mov_b32_dpp v115, v114 row_ror:8 row_mask:0xf bank_mask:0x3
    v_mfma_f32_32x32x16_bf16 a[16:31], v[76:79], a[160:163], a[16:31]
    ds_read_b128 a[192:195], v20 offset:64512
    buffer_load_dwordx4 v[152:155], v2, s[36:39], s71 offen offset:0
    v_cndmask_b32_dpp v250, v117, v116, vcc row_ror:8 row_mask:0xf bank_mask:0xf
    v_mov_b32_dpp v117, v116 row_ror:8 row_mask:0xf bank_mask:0x3
    v_mfma_f32_32x32x16_bf16 a[32:47], v[72:75], a[164:167], a[32:47]
    v_cndmask_b32_dpp v251, v119, v118, vcc row_ror:8 row_mask:0xf bank_mask:0xf
    v_mov_b32_dpp v119, v118 row_ror:8 row_mask:0xf bank_mask:0x3
    v_permlane16_swap_b32 v248, v249
    v_mfma_f32_32x32x16_bf16 a[48:63], v[76:79], a[164:167], a[48:63]
    ds_read_b128 a[196:199], v34 offset:64512
    v_permlane16_swap_b32 v113, v115
    buffer_load_dwordx4 v[156:159], v2, s[36:39], s71 offen offset:1024
    v_mfma_f32_32x32x16_bf16 a[64:79], v[72:75], a[168:171], a[64:79]
    v_permlane16_swap_b32 v250, v251
    v_permlane16_swap_b32 v117, v119
    v_perm_b32 v80, v250, v248, s69
    v_mfma_f32_32x32x16_bf16 a[80:95], v[76:79], a[168:171], a[80:95]
    ds_read_b128 a[200:203], v48 offset:64512
    s_mov_b32 s71, 1179648
    v_perm_b32 v82, v251, v249, s69
    v_perm_b32 v81, v117, v113, s69
    v_perm_b32 v83, v119, v115, s69
    v_mfma_f32_32x32x16_bf16 a[96:111], v[72:75], a[172:175], a[96:111]
    v_perm_b32 v84, v250, v248, s70
    buffer_load_dwordx4 v[160:163], v2, s[36:39], s71 offen offset:0
    v_perm_b32 v86, v251, v249, s70
    v_perm_b32 v85, v117, v113, s70
    v_mfma_f32_32x32x16_bf16 a[112:127], v[76:79], a[172:175], a[112:127]
    ds_read_b128 a[204:207], v62 offset:64512
    v_perm_b32 v87, v119, v115, s70
    s_nop 0
    s_waitcnt vmcnt(9) lgkmcnt(4)
    v_mfma_f32_32x32x16_bf16 a[0:15], v[80:83], a[176:179], a[0:15]
    v_cndmask_b32_dpp v248, v121, v120, vcc row_ror:8 row_mask:0xf bank_mask:0xf
    buffer_load_dwordx4 v[164:167], v2, s[36:39], s71 offen offset:1024
    v_mov_b32_dpp v121, v120 row_ror:8 row_mask:0xf bank_mask:0x3
    v_cndmask_b32_dpp v249, v123, v122, vcc row_ror:8 row_mask:0xf bank_mask:0xf
    v_mov_b32_dpp v123, v122 row_ror:8 row_mask:0xf bank_mask:0x3
    v_mfma_f32_32x32x16_bf16 a[16:31], v[84:87], a[176:179], a[16:31]
    ds_read_b128 a[208:211], v21 offset:64512
    v_cndmask_b32_dpp v250, v125, v124, vcc row_ror:8 row_mask:0xf bank_mask:0xf
    v_mov_b32_dpp v125, v124 row_ror:8 row_mask:0xf bank_mask:0x3
    v_lshrrev_b32 v225, 5, v1
    v_cndmask_b32_dpp v251, v127, v126, vcc row_ror:8 row_mask:0xf bank_mask:0xf
    v_mov_b32_dpp v127, v126 row_ror:8 row_mask:0xf bank_mask:0x3
    v_mfma_f32_32x32x16_bf16 a[32:47], v[80:83], a[180:183], a[32:47]
    v_permlane16_swap_b32 v248, v249
    v_lshlrev_b32 v225, 6, v225
    v_permlane16_swap_b32 v121, v123
    s_lshl_b32 s81, s65, 7
    v_mfma_f32_32x32x16_bf16 a[48:63], v[84:87], a[180:183], a[48:63]
    ds_read_b128 a[212:215], v35 offset:64512
    v_permlane16_swap_b32 v250, v251
    s_mov_b32 s71, 1310720
    v_permlane16_swap_b32 v125, v127
    v_mfma_f32_32x32x16_bf16 a[64:79], v[80:83], a[184:187], a[64:79]
    v_perm_b32 v72, v250, v248, s69
    buffer_load_dwordx4 v[168:171], v2, s[36:39], s71 offen offset:0
    v_perm_b32 v74, v251, v249, s69
    v_perm_b32 v73, v125, v121, s69
    v_perm_b32 v75, v127, v123, s69
    v_mfma_f32_32x32x16_bf16 a[80:95], v[84:87], a[184:187], a[80:95]
    ds_read_b128 a[216:219], v49 offset:64512
    v_perm_b32 v76, v250, v248, s70
    v_perm_b32 v78, v251, v249, s70
    buffer_load_dwordx4 v[172:175], v2, s[36:39], s71 offen offset:1024
    v_perm_b32 v77, v125, v121, s70
    v_mfma_f32_32x32x16_bf16 a[96:111], v[80:83], a[188:191], a[96:111]
    v_perm_b32 v79, v127, v123, s70
    v_mfma_f32_32x32x16_bf16 a[112:127], v[84:87], a[188:191], a[112:127]
    ds_read_b128 a[220:223], v63 offset:64512
    s_waitcnt vmcnt(10) lgkmcnt(4)
    v_mfma_f32_32x32x16_bf16 a[0:15], v[72:75], a[192:195], a[0:15]
    v_cndmask_b32_dpp v248, v129, v128, vcc row_ror:8 row_mask:0xf bank_mask:0xf
    s_mov_b32 s71, 1441792
    v_mov_b32_dpp v129, v128 row_ror:8 row_mask:0xf bank_mask:0x3
    buffer_load_dwordx4 v[176:179], v2, s[36:39], s71 offen offset:0
    v_cndmask_b32_dpp v249, v131, v130, vcc row_ror:8 row_mask:0xf bank_mask:0xf
    v_mfma_f32_32x32x16_bf16 a[16:31], v[76:79], a[192:195], a[16:31]
    ds_read_b128 a[224:227], v22 offset:64512
    v_mov_b32_dpp v131, v130 row_ror:8 row_mask:0xf bank_mask:0x3
    v_cndmask_b32_dpp v250, v133, v132, vcc row_ror:8 row_mask:0xf bank_mask:0xf
    v_mov_b32_dpp v133, v132 row_ror:8 row_mask:0xf bank_mask:0x3
    buffer_load_dwordx4 v[184:187], v225, s[44:47], s81 offen offset:0
    v_mfma_f32_32x32x16_bf16 a[32:47], v[72:75], a[196:199], a[32:47]
    v_cndmask_b32_dpp v251, v135, v134, vcc row_ror:8 row_mask:0xf bank_mask:0xf
    v_mov_b32_dpp v135, v134 row_ror:8 row_mask:0xf bank_mask:0x3
    v_permlane16_swap_b32 v248, v249
    buffer_load_dwordx4 v[180:183], v2, s[36:39], s71 offen offset:1024
    v_mfma_f32_32x32x16_bf16 a[48:63], v[76:79], a[196:199], a[48:63]
    ds_read_b128 a[228:231], v36 offset:64512
    v_permlane16_swap_b32 v129, v131
    v_permlane16_swap_b32 v250, v251
    v_mfma_f32_32x32x16_bf16 a[64:79], v[72:75], a[200:203], a[64:79]
    buffer_load_dwordx4 v[188:191], v225, s[44:47], s81 offen offset:16
    v_permlane16_swap_b32 v133, v135
    v_perm_b32 v80, v250, v248, s69
    v_perm_b32 v82, v251, v249, s69
    v_mfma_f32_32x32x16_bf16 a[80:95], v[76:79], a[200:203], a[80:95]
    ds_read_b128 a[232:235], v50 offset:64512
    s_mov_b32 s71, 1572864
    v_perm_b32 v81, v133, v129, s69
    v_perm_b32 v83, v135, v131, s69
    buffer_load_dwordx4 v[88:91], v2, s[36:39], s71 offen offset:0
    v_mfma_f32_32x32x16_bf16 a[96:111], v[72:75], a[204:207], a[96:111]
    v_perm_b32 v84, v250, v248, s70
    v_perm_b32 v86, v251, v249, s70
    v_perm_b32 v85, v133, v129, s70
    buffer_load_dwordx4 v[192:195], v225, s[44:47], s81 offen offset:32
    v_perm_b32 v87, v135, v131, s70
    v_mfma_f32_32x32x16_bf16 a[112:127], v[76:79], a[204:207], a[112:127]
    ds_read_b128 a[236:239], v64 offset:64512
    s_waitcnt vmcnt(14) lgkmcnt(4)
    v_mfma_f32_32x32x16_bf16 a[0:15], v[80:83], a[208:211], a[0:15]
    v_cndmask_b32_dpp v248, v137, v136, vcc row_ror:8 row_mask:0xf bank_mask:0xf
    buffer_load_dwordx4 v[92:95], v2, s[36:39], s71 offen offset:1024
    v_mov_b32_dpp v137, v136 row_ror:8 row_mask:0xf bank_mask:0x3
    v_cndmask_b32_dpp v249, v139, v138, vcc row_ror:8 row_mask:0xf bank_mask:0xf
    v_mov_b32_dpp v139, v138 row_ror:8 row_mask:0xf bank_mask:0x3
    v_mfma_f32_32x32x16_bf16 a[16:31], v[84:87], a[208:211], a[16:31]
    ds_read_b128 a[240:243], v23 offset:64512
    v_cndmask_b32_dpp v250, v141, v140, vcc row_ror:8 row_mask:0xf bank_mask:0xf
    buffer_load_dwordx4 v[196:199], v225, s[44:47], s81 offen offset:48
    v_mov_b32_dpp v141, v140 row_ror:8 row_mask:0xf bank_mask:0x3
    v_cndmask_b32_dpp v251, v143, v142, vcc row_ror:8 row_mask:0xf bank_mask:0xf
    v_mfma_f32_32x32x16_bf16 a[32:47], v[80:83], a[212:215], a[32:47]
    v_mov_b32_dpp v143, v142 row_ror:8 row_mask:0xf bank_mask:0x3
    v_permlane16_swap_b32 v248, v249
    s_mov_b32 s71, 32768
    v_permlane16_swap_b32 v137, v139
    v_mfma_f32_32x32x16_bf16 a[48:63], v[84:87], a[212:215], a[48:63]
    ds_read_b128 a[244:247], v37 offset:64512
    buffer_load_dwordx4 v[96:99], v2, s[36:39], s71 offen offset:0
    v_permlane16_swap_b32 v250, v251
    v_mfma_f32_32x32x16_bf16 a[64:79], v[80:83], a[216:219], a[64:79]
    v_permlane16_swap_b32 v141, v143
    buffer_load_dwordx4 v[200:203], v225, s[48:51], s81 offen offset:0
    v_perm_b32 v72, v250, v248, s69
    v_perm_b32 v74, v251, v249, s69
    v_mfma_f32_32x32x16_bf16 a[80:95], v[84:87], a[216:219], a[80:95]
    ds_read_b128 a[248:251], v51 offset:64512
    v_perm_b32 v73, v141, v137, s69
    buffer_load_dwordx4 v[100:103], v2, s[36:39], s71 offen offset:1024
    v_perm_b32 v75, v143, v139, s69
    v_perm_b32 v76, v250, v248, s70
    v_mfma_f32_32x32x16_bf16 a[96:111], v[80:83], a[220:223], a[96:111]
    v_perm_b32 v78, v251, v249, s70
    v_perm_b32 v77, v141, v137, s70
    buffer_load_dwordx4 v[204:207], v225, s[48:51], s81 offen offset:16
    v_perm_b32 v79, v143, v139, s70
    v_mfma_f32_32x32x16_bf16 a[112:127], v[84:87], a[220:223], a[112:127]
    ds_read_b128 a[252:255], v65 offset:64512
    s_waitcnt vmcnt(18) lgkmcnt(4)
    v_mfma_f32_32x32x16_bf16 a[0:15], v[72:75], a[224:227], a[0:15]
    v_cndmask_b32_dpp v248, v145, v144, vcc row_ror:8 row_mask:0xf bank_mask:0xf
    s_mov_b32 s71, 163840
    v_mov_b32_dpp v145, v144 row_ror:8 row_mask:0xf bank_mask:0x3
    v_cndmask_b32_dpp v249, v147, v146, vcc row_ror:8 row_mask:0xf bank_mask:0xf
    buffer_load_dwordx4 v[104:107], v2, s[36:39], s71 offen offset:0
    v_mfma_f32_32x32x16_bf16 a[16:31], v[76:79], a[224:227], a[16:31]
    ds_read_b128 a[128:131], v24 offset:64512
    v_mov_b32_dpp v147, v146 row_ror:8 row_mask:0xf bank_mask:0x3
    v_cndmask_b32_dpp v250, v149, v148, vcc row_ror:8 row_mask:0xf bank_mask:0xf
    v_mov_b32_dpp v149, v148 row_ror:8 row_mask:0xf bank_mask:0x3
    v_cndmask_b32_dpp v251, v151, v150, vcc row_ror:8 row_mask:0xf bank_mask:0xf
    v_mfma_f32_32x32x16_bf16 a[32:47], v[72:75], a[228:231], a[32:47]
    buffer_load_dwordx4 v[208:211], v225, s[48:51], s81 offen offset:32
    v_mov_b32_dpp v151, v150 row_ror:8 row_mask:0xf bank_mask:0x3
    v_permlane16_swap_b32 v248, v249
    v_mfma_f32_32x32x16_bf16 a[48:63], v[76:79], a[228:231], a[48:63]
    ds_read_b128 a[132:135], v38 offset:64512
    v_permlane16_swap_b32 v145, v147
    buffer_load_dwordx4 v[108:111], v2, s[36:39], s71 offen offset:1024
    v_mfma_f32_32x32x16_bf16 a[64:79], v[72:75], a[232:235], a[64:79]
    v_permlane16_swap_b32 v250, v251
    v_permlane16_swap_b32 v149, v151
    buffer_load_dwordx4 v[212:215], v225, s[48:51], s81 offen offset:48
    v_mfma_f32_32x32x16_bf16 a[80:95], v[76:79], a[232:235], a[80:95]
    ds_read_b128 a[136:139], v52 offset:64512
    v_perm_b32 v80, v250, v248, s69
    v_perm_b32 v82, v251, v249, s69
    v_perm_b32 v81, v149, v145, s69
    s_mov_b32 s71, 294912
    v_perm_b32 v83, v151, v147, s69
    v_mfma_f32_32x32x16_bf16 a[96:111], v[72:75], a[236:239], a[96:111]
    v_perm_b32 v84, v250, v248, s70
    buffer_load_dwordx4 v[112:115], v2, s[36:39], s71 offen offset:0
    v_perm_b32 v86, v251, v249, s70
    v_perm_b32 v85, v149, v145, s70
    v_perm_b32 v87, v151, v147, s70
    v_mfma_f32_32x32x16_bf16 a[112:127], v[76:79], a[236:239], a[112:127]
    ds_read_b128 a[140:143], v66 offset:64512
    s_lshl_b32 s82, s66, 2
    s_waitcnt vmcnt(21) lgkmcnt(4)
    v_mfma_f32_32x32x16_bf16 a[0:15], v[80:83], a[240:243], a[0:15]
    v_cndmask_b32_dpp v248, v153, v152, vcc row_ror:8 row_mask:0xf bank_mask:0xf
    buffer_load_dwordx4 v[116:119], v2, s[36:39], s71 offen offset:1024
    v_mov_b32_dpp v153, v152 row_ror:8 row_mask:0xf bank_mask:0x3
    v_cndmask_b32_dpp v249, v155, v154, vcc row_ror:8 row_mask:0xf bank_mask:0xf
    v_mov_b32_dpp v155, v154 row_ror:8 row_mask:0xf bank_mask:0x3
    v_mfma_f32_32x32x16_bf16 a[16:31], v[84:87], a[240:243], a[16:31]
    ds_read_b128 a[144:147], v25 offset:64512
    v_cndmask_b32_dpp v250, v157, v156, vcc row_ror:8 row_mask:0xf bank_mask:0xf
    v_mov_b32_dpp v157, v156 row_ror:8 row_mask:0xf bank_mask:0x3
    s_add_u32 s82, s82, s64
    v_cndmask_b32_dpp v251, v159, v158, vcc row_ror:8 row_mask:0xf bank_mask:0xf
    v_mov_b32_dpp v159, v158 row_ror:8 row_mask:0xf bank_mask:0x3
    v_mfma_f32_32x32x16_bf16 a[32:47], v[80:83], a[244:247], a[32:47]
    v_permlane16_swap_b32 v248, v249
    s_mul_i32 s82, s82, 832
    v_permlane16_swap_b32 v153, v155
    v_mul_u32_u24 v10, 26, v4
    v_mfma_f32_32x32x16_bf16 a[48:63], v[84:87], a[244:247], a[48:63]
    ds_read_b128 a[148:151], v39 offset:64512
    v_permlane16_swap_b32 v250, v251
    s_mov_b32 s71, 425984
    v_permlane16_swap_b32 v157, v159
    v_mfma_f32_32x32x16_bf16 a[64:79], v[80:83], a[248:251], a[64:79]
    v_perm_b32 v72, v250, v248, s69
    buffer_load_dwordx4 v[120:123], v2, s[36:39], s71 offen offset:0
    v_perm_b32 v74, v251, v249, s69
    v_perm_b32 v73, v157, v153, s69
    v_perm_b32 v75, v159, v155, s69
    v_mfma_f32_32x32x16_bf16 a[80:95], v[84:87], a[248:251], a[80:95]
    ds_read_b128 a[152:155], v53 offset:64512
    v_perm_b32 v76, v250, v248, s70
    v_perm_b32 v78, v251, v249, s70
    buffer_load_dwordx4 v[124:127], v2, s[36:39], s71 offen offset:1024
    v_perm_b32 v77, v157, v153, s70
    v_mfma_f32_32x32x16_bf16 a[96:111], v[80:83], a[252:255], a[96:111]
    v_perm_b32 v79, v159, v155, s70
    v_mfma_f32_32x32x16_bf16 a[112:127], v[84:87], a[252:255], a[112:127]
    ds_read_b128 a[156:159], v67 offset:64512
    s_waitcnt vmcnt(22) lgkmcnt(4)
    v_mfma_f32_32x32x16_bf16 a[0:15], v[72:75], a[128:131], a[0:15]
    v_cndmask_b32_dpp v248, v161, v160, vcc row_ror:8 row_mask:0xf bank_mask:0xf
    s_mov_b32 s71, 557056
    v_mov_b32_dpp v161, v160 row_ror:8 row_mask:0xf bank_mask:0x3
    v_cndmask_b32_dpp v249, v163, v162, vcc row_ror:8 row_mask:0xf bank_mask:0xf
    buffer_load_dwordx4 v[128:131], v2, s[36:39], s71 offen offset:0
    v_mfma_f32_32x32x16_bf16 a[16:31], v[76:79], a[128:131], a[16:31]
    ds_read_b128 a[160:163], v26 offset:64512
    v_mov_b32_dpp v163, v162 row_ror:8 row_mask:0xf bank_mask:0x3
    v_cndmask_b32_dpp v250, v165, v164, vcc row_ror:8 row_mask:0xf bank_mask:0xf
    v_mov_b32_dpp v165, v164 row_ror:8 row_mask:0xf bank_mask:0x3
    v_cndmask_b32_dpp v251, v167, v166, vcc row_ror:8 row_mask:0xf bank_mask:0xf
    v_and_b32 v10, -4, v10
    v_mfma_f32_32x32x16_bf16 a[32:47], v[72:75], a[132:135], a[32:47]
    v_mov_b32_dpp v167, v166 row_ror:8 row_mask:0xf bank_mask:0x3
    v_permlane16_swap_b32 v248, v249
    buffer_load_dwordx4 v[216:219], v10, s[40:43], s82 offen
    v_mfma_f32_32x32x16_bf16 a[48:63], v[76:79], a[132:135], a[48:63]
    ds_read_b128 a[164:167], v40 offset:64512
    v_permlane16_swap_b32 v161, v163
    v_permlane16_swap_b32 v250, v251
    v_mfma_f32_32x32x16_bf16 a[64:79], v[72:75], a[136:139], a[64:79]
    buffer_load_dwordx4 v[132:135], v2, s[36:39], s71 offen offset:1024
    v_permlane16_swap_b32 v165, v167
    v_perm_b32 v80, v250, v248, s69
    v_mfma_f32_32x32x16_bf16 a[80:95], v[76:79], a[136:139], a[80:95]
    ds_read_b128 a[168:171], v54 offset:64512
    buffer_load_dwordx3 v[220:222], v10, s[40:43], s82 offen offset:16
    v_perm_b32 v82, v251, v249, s69
    v_perm_b32 v81, v165, v161, s69
    v_perm_b32 v83, v167, v163, s69
    v_mfma_f32_32x32x16_bf16 a[96:111], v[72:75], a[140:143], a[96:111]
    v_perm_b32 v84, v250, v248, s70
    s_mov_b32 s71, 688128
    v_perm_b32 v86, v251, v249, s70
    v_perm_b32 v85, v165, v161, s70
    buffer_load_dwordx4 v[136:139], v2, s[36:39], s71 offen offset:0
    v_mfma_f32_32x32x16_bf16 a[112:127], v[76:79], a[140:143], a[112:127]
    ds_read_b128 a[172:175], v68 offset:64512
    v_perm_b32 v87, v167, v163, s70
    s_nop 0
    s_waitcnt vmcnt(25) lgkmcnt(4)
    v_mfma_f32_32x32x16_bf16 a[0:15], v[80:83], a[144:147], a[0:15]
    v_cndmask_b32_dpp v248, v169, v168, vcc row_ror:8 row_mask:0xf bank_mask:0xf
    buffer_load_dwordx4 v[140:143], v2, s[36:39], s71 offen offset:1024
    v_mov_b32_dpp v169, v168 row_ror:8 row_mask:0xf bank_mask:0x3
    v_cndmask_b32_dpp v249, v171, v170, vcc row_ror:8 row_mask:0xf bank_mask:0xf
    v_mfma_f32_32x32x16_bf16 a[16:31], v[84:87], a[144:147], a[16:31]
    ds_read_b128 a[176:179], v27 offset:64512
    v_mov_b32_dpp v171, v170 row_ror:8 row_mask:0xf bank_mask:0x3
    v_cndmask_b32_dpp v250, v173, v172, vcc row_ror:8 row_mask:0xf bank_mask:0xf
    v_mov_b32_dpp v173, v172 row_ror:8 row_mask:0xf bank_mask:0x3
    v_cndmask_b32_dpp v251, v175, v174, vcc row_ror:8 row_mask:0xf bank_mask:0xf
    v_mfma_f32_32x32x16_bf16 a[32:47], v[80:83], a[148:151], a[32:47]
    v_mov_b32_dpp v175, v174 row_ror:8 row_mask:0xf bank_mask:0x3
    s_mov_b32 s71, 819200
    v_permlane16_swap_b32 v248, v249
    v_mfma_f32_32x32x16_bf16 a[48:63], v[84:87], a[148:151], a[48:63]
    ds_read_b128 a[180:183], v41 offset:64512
    v_permlane16_swap_b32 v169, v171
    buffer_load_dwordx4 v[144:147], v2, s[36:39], s71 offen offset:0
    v_mfma_f32_32x32x16_bf16 a[64:79], v[80:83], a[152:155], a[64:79]
    v_permlane16_swap_b32 v250, v251
    v_permlane16_swap_b32 v173, v175
    v_perm_b32 v72, v250, v248, s69
    v_mfma_f32_32x32x16_bf16 a[80:95], v[84:87], a[152:155], a[80:95]
    ds_read_b128 a[184:187], v55 offset:64512
    v_perm_b32 v74, v251, v249, s69
    v_perm_b32 v73, v173, v169, s69
    v_perm_b32 v75, v175, v171, s69
    v_mfma_f32_32x32x16_bf16 a[96:111], v[80:83], a[156:159], a[96:111]
    buffer_load_dwordx4 v[148:151], v2, s[36:39], s71 offen offset:1024
    v_perm_b32 v76, v250, v248, s70
    v_perm_b32 v78, v251, v249, s70
    v_perm_b32 v77, v173, v169, s70
    v_mfma_f32_32x32x16_bf16 a[112:127], v[84:87], a[156:159], a[112:127]
    ds_read_b128 a[188:191], v69 offset:64512
    v_perm_b32 v79, v175, v171, s70
    s_nop 0
    s_waitcnt vmcnt(25) lgkmcnt(4)
    v_mfma_f32_32x32x16_bf16 a[0:15], v[72:75], a[160:163], a[0:15]
    v_cndmask_b32_dpp v248, v177, v176, vcc row_ror:8 row_mask:0xf bank_mask:0xf
    s_mov_b32 s71, 950272
    v_mov_b32_dpp v177, v176 row_ror:8 row_mask:0xf bank_mask:0x3
    v_cndmask_b32_dpp v249, v179, v178, vcc row_ror:8 row_mask:0xf bank_mask:0xf
    v_mov_b32_dpp v179, v178 row_ror:8 row_mask:0xf bank_mask:0x3
    v_mfma_f32_32x32x16_bf16 a[16:31], v[76:79], a[160:163], a[16:31]
    ds_read_b128 a[192:195], v28 offset:64512
    buffer_load_dwordx4 v[152:155], v2, s[36:39], s71 offen offset:0
    v_cndmask_b32_dpp v250, v181, v180, vcc row_ror:8 row_mask:0xf bank_mask:0xf
    v_mov_b32_dpp v181, v180 row_ror:8 row_mask:0xf bank_mask:0x3
    v_mfma_f32_32x32x16_bf16 a[32:47], v[72:75], a[164:167], a[32:47]
    v_cndmask_b32_dpp v251, v183, v182, vcc row_ror:8 row_mask:0xf bank_mask:0xf
    v_mov_b32_dpp v183, v182 row_ror:8 row_mask:0xf bank_mask:0x3
    v_permlane16_swap_b32 v248, v249
    v_mfma_f32_32x32x16_bf16 a[48:63], v[76:79], a[164:167], a[48:63]
    ds_read_b128 a[196:199], v42 offset:64512
    v_permlane16_swap_b32 v177, v179
    buffer_load_dwordx4 v[156:159], v2, s[36:39], s71 offen offset:1024
    v_mfma_f32_32x32x16_bf16 a[64:79], v[72:75], a[168:171], a[64:79]
    v_permlane16_swap_b32 v250, v251
    v_permlane16_swap_b32 v181, v183
    v_perm_b32 v80, v250, v248, s69
    v_mfma_f32_32x32x16_bf16 a[80:95], v[76:79], a[168:171], a[80:95]
    ds_read_b128 a[200:203], v56 offset:64512
    s_mov_b32 s71, 1081344
    v_perm_b32 v82, v251, v249, s69
    v_perm_b32 v81, v181, v177, s69
    v_perm_b32 v83, v183, v179, s69
    v_mfma_f32_32x32x16_bf16 a[96:111], v[72:75], a[172:175], a[96:111]
    v_perm_b32 v84, v250, v248, s70
    buffer_load_dwordx4 v[160:163], v2, s[36:39], s71 offen offset:0
    v_perm_b32 v86, v251, v249, s70
    v_perm_b32 v85, v181, v177, s70
    v_mfma_f32_32x32x16_bf16 a[112:127], v[76:79], a[172:175], a[112:127]
    ds_read_b128 a[204:207], v70 offset:64512
    v_perm_b32 v87, v183, v179, s70
    s_nop 0
    s_waitcnt vmcnt(24) lgkmcnt(4)
    v_mfma_f32_32x32x16_bf16 a[0:15], v[80:83], a[176:179], a[0:15]
    v_cndmask_b32_dpp v248, v89, v88, vcc row_ror:8 row_mask:0xf bank_mask:0xf
    buffer_load_dwordx4 v[164:167], v2, s[36:39], s71 offen offset:1024
    v_mov_b32_dpp v89, v88 row_ror:8 row_mask:0xf bank_mask:0x3
    v_cndmask_b32_dpp v249, v91, v90, vcc row_ror:8 row_mask:0xf bank_mask:0xf
    v_mfma_f32_32x32x16_bf16 a[16:31], v[84:87], a[176:179], a[16:31]
    v_mov_b32_dpp v91, v90 row_ror:8 row_mask:0xf bank_mask:0x3
    v_cndmask_b32_dpp v250, v93, v92, vcc row_ror:8 row_mask:0xf bank_mask:0xf
    v_mov_b32_dpp v93, v92 row_ror:8 row_mask:0xf bank_mask:0x3
    v_cndmask_b32_dpp v251, v95, v94, vcc row_ror:8 row_mask:0xf bank_mask:0xf
    v_mov_b32_dpp v95, v94 row_ror:8 row_mask:0xf bank_mask:0x3
    v_mfma_f32_32x32x16_bf16 a[32:47], v[80:83], a[180:183], a[32:47]
    v_permlane16_swap_b32 v248, v249
    v_permlane16_swap_b32 v89, v91
    v_mfma_f32_32x32x16_bf16 a[48:63], v[84:87], a[180:183], a[48:63]
    s_waitcnt lgkmcnt(0)
    s_barrier
    ds_read_b128 a[208:211], v16 offset:0
    v_permlane16_swap_b32 v250, v251
    v_mfma_f32_32x32x16_bf16 a[64:79], v[80:83], a[184:187], a[64:79]
    ds_read_b128 a[212:215], v30 offset:0
    v_permlane16_swap_b32 v93, v95
    v_perm_b32 v72, v250, v248, s69
    v_perm_b32 v74, v251, v249, s69
    v_mfma_f32_32x32x16_bf16 a[80:95], v[84:87], a[184:187], a[80:95]
    ds_read_b128 a[216:219], v44 offset:0
    v_perm_b32 v73, v93, v89, s69
    v_perm_b32 v75, v95, v91, s69
    v_perm_b32 v76, v250, v248, s70
    v_perm_b32 v78, v251, v249, s70
    v_mfma_f32_32x32x16_bf16 a[96:111], v[80:83], a[188:191], a[96:111]
    v_perm_b32 v77, v93, v89, s70
    v_perm_b32 v79, v95, v91, s70
    v_mfma_f32_32x32x16_bf16 a[112:127], v[84:87], a[188:191], a[112:127]
    ds_read_b128 a[220:223], v58 offset:0
    s_waitcnt vmcnt(21)
    v_mfma_f32_32x32x16_bf16 a[0:15], v[72:75], a[192:195], a[0:15]
    v_cndmask_b32_dpp v248, v97, v96, vcc row_ror:8 row_mask:0xf bank_mask:0xf
    s_mov_b32 s71, 1212416
    v_mov_b32_dpp v97, v96 row_ror:8 row_mask:0xf bank_mask:0x3
    buffer_load_dwordx4 v[168:171], v2, s[36:39], s71 offen offset:0
    v_cndmask_b32_dpp v249, v99, v98, vcc row_ror:8 row_mask:0xf bank_mask:0xf
    v_mfma_f32_32x32x16_bf16 a[16:31], v[76:79], a[192:195], a[16:31]
    ds_read_b128 a[224:227], v17 offset:0
    v_mov_b32_dpp v99, v98 row_ror:8 row_mask:0xf bank_mask:0x3
    v_cndmask_b32_dpp v250, v101, v100, vcc row_ror:8 row_mask:0xf bank_mask:0xf
    v_mov_b32_dpp v101, v100 row_ror:8 row_mask:0xf bank_mask:0x3
    s_add_u32 m0, s85, 99328
    v_cndmask_b32_dpp v251, v103, v102, vcc row_ror:8 row_mask:0xf bank_mask:0xf
    v_mfma_f32_32x32x16_bf16 a[32:47], v[72:75], a[196:199], a[32:47]
    v_mov_b32_dpp v103, v102 row_ror:8 row_mask:0xf bank_mask:0x3
    s_add_u32 s89, s86, 128
    v_permlane16_swap_b32 v248, v249
    buffer_load_dwordx4 v3, s[32:35], s89 offen lds
    v_mfma_f32_32x32x16_bf16 a[48:63], v[76:79], a[196:199], a[48:63]
    ds_read_b128 a[228:231], v31 offset:0
    v_permlane16_swap_b32 v97, v99
    v_permlane16_swap_b32 v250, v251
    s_add_u32 m0, s85, 0
    v_mfma_f32_32x32x16_bf16 a[64:79], v[72:75], a[200:203], a[64:79]
    v_permlane16_swap_b32 v101, v103
    buffer_load_dwordx4 v254, s[32:35], s89 offen lds
    v_perm_b32 v80, v250, v248, s69
    v_perm_b32 v82, v251, v249, s69
    v_mfma_f32_32x32x16_bf16 a[80:95], v[76:79], a[200:203], a[80:95]
    ds_read_b128 a[232:235], v45 offset:0
    v_perm_b32 v81, v101, v97, s69
    v_perm_b32 v83, v103, v99, s69
    s_add_u32 m0, s85, 132096
    v_perm_b32 v84, v250, v248, s70
    s_add_u32 s89, s86, 131200
    v_mfma_f32_32x32x16_bf16 a[96:111], v[72:75], a[204:207], a[96:111]
    v_perm_b32 v86, v251, v249, s70
    v_perm_b32 v85, v101, v97, s70
    buffer_load_dwordx4 v3, s[32:35], s89 offen lds
    v_perm_b32 v87, v103, v99, s70
    v_mfma_f32_32x32x16_bf16 a[112:127], v[76:79], a[204:207], a[112:127]
    ds_read_b128 a[236:239], v59 offset:0
    s_waitcnt vmcnt(21) lgkmcnt(4)
    v_mfma_f32_32x32x16_bf16 a[0:15], v[80:83], a[208:211], a[0:15]
    v_cndmask_b32_dpp v248, v105, v104, vcc row_ror:8 row_mask:0xf bank_mask:0xf
    buffer_load_dwordx4 v[172:175], v2, s[36:39], s71 offen offset:1024
    v_mov_b32_dpp v105, v104 row_ror:8 row_mask:0xf bank_mask:0x3
    v_cndmask_b32_dpp v249, v107, v106, vcc row_ror:8 row_mask:0xf bank_mask:0xf
    v_mfma_f32_32x32x16_bf16 a[16:31], v[84:87], a[208:211], a[16:31]
    ds_read_b128 a[240:243], v18 offset:0
    v_mov_b32_dpp v107, v106 row_ror:8 row_mask:0xf bank_mask:0x3
    v_cndmask_b32_dpp v250, v109, v108, vcc row_ror:8 row_mask:0xf bank_mask:0xf
    v_mov_b32_dpp v109, v108 row_ror:8 row_mask:0xf bank_mask:0x3
    s_add_u32 m0, s85, 103424
    v_mfma_f32_32x32x16_bf16 a[32:47], v[80:83], a[212:215], a[32:47]
    v_cndmask_b32_dpp v251, v111, v110, vcc row_ror:8 row_mask:0xf bank_mask:0xf
    v_mov_b32_dpp v111, v110 row_ror:8 row_mask:0xf bank_mask:0x3
    v_permlane16_swap_b32 v248, v249
    s_add_u32 s89, s86, 16512
    v_mfma_f32_32x32x16_bf16 a[48:63], v[84:87], a[212:215], a[48:63]
    ds_read_b128 a[244:247], v32 offset:0
    v_permlane16_swap_b32 v105, v107
    buffer_load_dwordx4 v3, s[32:35], s89 offen lds
    v_mfma_f32_32x32x16_bf16 a[64:79], v[80:83], a[216:219], a[64:79]
    v_permlane16_swap_b32 v250, v251
    v_permlane16_swap_b32 v109, v111
    v_perm_b32 v72, v250, v248, s69
    v_mfma_f32_32x32x16_bf16 a[80:95], v[84:87], a[216:219], a[80:95]
    ds_read_b128 a[248:251], v46 offset:0
    v_perm_b32 v74, v251, v249, s69
    s_add_u32 m0, s85, 4096
    v_perm_b32 v73, v109, v105, s69
    v_perm_b32 v75, v111, v107, s69
    v_mfma_f32_32x32x16_bf16 a[96:111], v[80:83], a[220:223], a[96:111]
    v_perm_b32 v76, v250, v248, s70
    buffer_load_dwordx4 v254, s[32:35], s89 offen lds
    v_perm_b32 v78, v251, v249, s70
    v_perm_b32 v77, v109, v105, s70
    v_mfma_f32_32x32x16_bf16 a[112:127], v[84:87], a[220:223], a[112:127]
    ds_read_b128 a[252:255], v60 offset:0
    v_perm_b32 v79, v111, v107, s70
    s_nop 0
    s_waitcnt vmcnt(21) lgkmcnt(4)
    v_mfma_f32_32x32x16_bf16 a[0:15], v[72:75], a[224:227], a[0:15]
    v_cndmask_b32_dpp v248, v113, v112, vcc row_ror:8 row_mask:0xf bank_mask:0xf
    s_mov_b32 s71, 1343488
    v_mov_b32_dpp v113, v112 row_ror:8 row_mask:0xf bank_mask:0x3
    buffer_load_dwordx4 v[176:179], v2, s[36:39], s71 offen offset:0
    v_cndmask_b32_dpp v249, v115, v114, vcc row_ror:8 row_mask:0xf bank_mask:0xf
    v_mfma_f32_32x32x16_bf16 a[16:31], v[76:79], a[224:227], a[16:31]
    ds_read_b128 a[128:131], v19 offset:0
    v_mov_b32_dpp v115, v114 row_ror:8 row_mask:0xf bank_mask:0x3
    v_cndmask_b32_dpp v250, v117, v116, vcc row_ror:8 row_mask:0xf bank_mask:0xf
    v_mov_b32_dpp v117, v116 row_ror:8 row_mask:0xf bank_mask:0x3
    s_add_u32 m0, s85, 136192
    v_cndmask_b32_dpp v251, v119, v118, vcc row_ror:8 row_mask:0xf bank_mask:0xf
    v_mfma_f32_32x32x16_bf16 a[32:47], v[72:75], a[228:231], a[32:47]
    v_mov_b32_dpp v119, v118 row_ror:8 row_mask:0xf bank_mask:0x3
    s_add_u32 s89, s86, 147584
    v_permlane16_swap_b32 v248, v249
    buffer_load_dwordx4 v3, s[32:35], s89 offen lds
    v_mfma_f32_32x32x16_bf16 a[48:63], v[76:79], a[228:231], a[48:63]
    ds_read_b128 a[132:135], v33 offset:0
    v_permlane16_swap_b32 v113, v115
    v_permlane16_swap_b32 v250, v251
    s_add_u32 m0, s85, 107520
    v_mfma_f32_32x32x16_bf16 a[64:79], v[72:75], a[232:235], a[64:79]
    v_permlane16_swap_b32 v117, v119
    s_add_u32 s89, s86, 32896
    v_perm_b32 v80, v250, v248, s69
    v_perm_b32 v82, v251, v249, s69
    v_mfma_f32_32x32x16_bf16 a[80:95], v[76:79], a[232:235], a[80:95]
    ds_read_b128 a[136:139], v47 offset:0
    buffer_load_dwordx4 v3, s[32:35], s89 offen lds
    v_perm_b32 v81, v117, v113, s69
    v_perm_b32 v83, v119, v115, s69
    v_perm_b32 v84, v250, v248, s70
    v_mfma_f32_32x32x16_bf16 a[96:111], v[72:75], a[236:239], a[96:111]
    s_add_u32 m0, s85, 8192
    v_perm_b32 v86, v251, v249, s70
    v_perm_b32 v85, v117, v113, s70
    buffer_load_dwordx4 v254, s[32:35], s89 offen lds
    v_perm_b32 v87, v119, v115, s70
    v_mfma_f32_32x32x16_bf16 a[112:127], v[76:79], a[236:239], a[112:127]
    ds_read_b128 a[140:143], v61 offset:0
    s_waitcnt vmcnt(23) lgkmcnt(4)
    v_mfma_f32_32x32x16_bf16 a[0:15], v[80:83], a[240:243], a[0:15]
    v_cndmask_b32_dpp v248, v121, v120, vcc row_ror:8 row_mask:0xf bank_mask:0xf
    buffer_load_dwordx4 v[180:183], v2, s[36:39], s71 offen offset:1024
    v_mov_b32_dpp v121, v120 row_ror:8 row_mask:0xf bank_mask:0x3
    v_cndmask_b32_dpp v249, v123, v122, vcc row_ror:8 row_mask:0xf bank_mask:0xf
    v_mfma_f32_32x32x16_bf16 a[16:31], v[84:87], a[240:243], a[16:31]
    ds_read_b128 a[144:147], v20 offset:0
    v_mov_b32_dpp v123, v122 row_ror:8 row_mask:0xf bank_mask:0x3
    v_cndmask_b32_dpp v250, v125, v124, vcc row_ror:8 row_mask:0xf bank_mask:0xf
    v_mov_b32_dpp v125, v124 row_ror:8 row_mask:0xf bank_mask:0x3
    v_cndmask_b32_dpp v251, v127, v126, vcc row_ror:8 row_mask:0xf bank_mask:0xf
    v_mfma_f32_32x32x16_bf16 a[32:47], v[80:83], a[244:247], a[32:47]
    v_mov_b32_dpp v127, v126 row_ror:8 row_mask:0xf bank_mask:0x3
    v_permlane16_swap_b32 v248, v249
    s_add_u32 m0, s85, 140288
    v_mfma_f32_32x32x16_bf16 a[48:63], v[84:87], a[244:247], a[48:63]
    ds_read_b128 a[148:151], v34 offset:0
    v_permlane16_swap_b32 v121, v123
    v_permlane16_swap_b32 v250, v251
    v_mfma_f32_32x32x16_bf16 a[64:79], v[80:83], a[248:251], a[64:79]
    s_add_u32 s89, s86, 163968
    v_permlane16_swap_b32 v125, v127
    v_perm_b32 v72, v250, v248, s69
    v_perm_b32 v74, v251, v249, s69
    v_mfma_f32_32x32x16_bf16 a[80:95], v[84:87], a[248:251], a[80:95]
    ds_read_b128 a[152:155], v48 offset:0
    buffer_load_dwordx4 v3, s[32:35], s89 offen lds
    v_perm_b32 v73, v125, v121, s69
    v_perm_b32 v75, v127, v123, s69
    v_mfma_f32_32x32x16_bf16 a[96:111], v[80:83], a[252:255], a[96:111]
    v_perm_b32 v76, v250, v248, s70
    v_perm_b32 v78, v251, v249, s70
    v_perm_b32 v77, v125, v121, s70
    v_perm_b32 v79, v127, v123, s70
    v_mfma_f32_32x32x16_bf16 a[112:127], v[84:87], a[252:255], a[112:127]
    ds_read_b128 a[156:159], v62 offset:0
    s_waitcnt vmcnt(22) lgkmcnt(4)
    v_mfma_f32_32x32x16_bf16 a[0:15], v[72:75], a[128:131], a[0:15]
    v_cndmask_b32_dpp v248, v129, v128, vcc row_ror:8 row_mask:0xf bank_mask:0xf
    s_mov_b32 s71, 1474560
    v_mov_b32_dpp v129, v128 row_ror:8 row_mask:0xf bank_mask:0x3
    buffer_load_dwordx4 v[88:91], v2, s[36:39], s71 offen offset:0
    v_cndmask_b32_dpp v249, v131, v130, vcc row_ror:8 row_mask:0xf bank_mask:0xf
    v_mfma_f32_32x32x16_bf16 a[16:31], v[76:79], a[128:131], a[16:31]
    ds_read_b128 a[160:163], v21 offset:0
    v_mov_b32_dpp v131, v130 row_ror:8 row_mask:0xf bank_mask:0x3
    v_cndmask_b32_dpp v250, v133, v132, vcc row_ror:8 row_mask:0xf bank_mask:0xf
    v_mov_b32_dpp v133, v132 row_ror:8 row_mask:0xf bank_mask:0x3
    s_add_u32 m0, s85, 111616
    v_cndmask_b32_dpp v251, v135, v134, vcc row_ror:8 row_mask:0xf bank_mask:0xf
    v_mfma_f32_32x32x16_bf16 a[32:47], v[72:75], a[132:135], a[32:47]
    v_mov_b32_dpp v135, v134 row_ror:8 row_mask:0xf bank_mask:0x3
    s_add_u32 s89, s86, 49280
    v_permlane16_swap_b32 v248, v249
    buffer_load_dwordx4 v3, s[32:35], s89 offen lds
    v_mfma_f32_32x32x16_bf16 a[48:63], v[76:79], a[132:135], a[48:63]
    ds_read_b128 a[164:167], v35 offset:0
    v_permlane16_swap_b32 v129, v131
    v_permlane16_swap_b32 v250, v251
    s_add_u32 m0, s85, 12288
    v_mfma_f32_32x32x16_bf16 a[64:79], v[72:75], a[136:139], a[64:79]
    v_permlane16_swap_b32 v133, v135
    buffer_load_dwordx4 v254, s[32:35], s89 offen lds
    v_perm_b32 v80, v250, v248, s69
    v_perm_b32 v82, v251, v249, s69
    v_mfma_f32_32x32x16_bf16 a[80:95], v[76:79], a[136:139], a[80:95]
    ds_read_b128 a[168:171], v49 offset:0
    v_perm_b32 v81, v133, v129, s69
    v_perm_b32 v83, v135, v131, s69
    s_add_u32 m0, s85, 144384
    v_perm_b32 v84, v250, v248, s70
    s_add_u32 s89, s86, 180352
    v_mfma_f32_32x32x16_bf16 a[96:111], v[72:75], a[140:143], a[96:111]
    v_perm_b32 v86, v251, v249, s70
    v_perm_b32 v85, v133, v129, s70
    buffer_load_dwordx4 v3, s[32:35], s89 offen lds
    v_perm_b32 v87, v135, v131, s70
    v_mfma_f32_32x32x16_bf16 a[112:127], v[76:79], a[140:143], a[112:127]
    ds_read_b128 a[172:175], v63 offset:0
    s_waitcnt vmcnt(23) lgkmcnt(4)
    v_mfma_f32_32x32x16_bf16 a[0:15], v[80:83], a[144:147], a[0:15]
    v_cndmask_b32_dpp v248, v137, v136, vcc row_ror:8 row_mask:0xf bank_mask:0xf
    buffer_load_dwordx4 v[92:95], v2, s[36:39], s71 offen offset:1024
    v_mov_b32_dpp v137, v136 row_ror:8 row_mask:0xf bank_mask:0x3
    v_cndmask_b32_dpp v249, v139, v138, vcc row_ror:8 row_mask:0xf bank_mask:0xf
    v_mfma_f32_32x32x16_bf16 a[16:31], v[84:87], a[144:147], a[16:31]
    ds_read_b128 a[176:179], v22 offset:0
    v_mov_b32_dpp v139, v138 row_ror:8 row_mask:0xf bank_mask:0x3
    v_cndmask_b32_dpp v250, v141, v140, vcc row_ror:8 row_mask:0xf bank_mask:0xf
    v_mov_b32_dpp v141, v140 row_ror:8 row_mask:0xf bank_mask:0x3
    s_add_u32 m0, s85, 115712
    v_mfma_f32_32x32x16_bf16 a[32:47], v[80:83], a[148:151], a[32:47]
    v_cndmask_b32_dpp v251, v143, v142, vcc row_ror:8 row_mask:0xf bank_mask:0xf
    v_mov_b32_dpp v143, v142 row_ror:8 row_mask:0xf bank_mask:0x3
    v_permlane16_swap_b32 v248, v249
    s_add_u32 s89, s86, 65664
    v_mfma_f32_32x32x16_bf16 a[48:63], v[84:87], a[148:151], a[48:63]
    ds_read_b128 a[180:183], v36 offset:0
    v_permlane16_swap_b32 v137, v139
    buffer_load_dwordx4 v3, s[32:35], s89 offen lds
    v_mfma_f32_32x32x16_bf16 a[64:79], v[80:83], a[152:155], a[64:79]
    v_permlane16_swap_b32 v250, v251
    v_permlane16_swap_b32 v141, v143
    v_perm_b32 v72, v250, v248, s69
    v_mfma_f32_32x32x16_bf16 a[80:95], v[84:87], a[152:155], a[80:95]
    ds_read_b128 a[184:187], v50 offset:0
    v_perm_b32 v74, v251, v249, s69
    s_add_u32 m0, s85, 16384
    v_perm_b32 v73, v141, v137, s69
    v_perm_b32 v75, v143, v139, s69
    v_mfma_f32_32x32x16_bf16 a[96:111], v[80:83], a[156:159], a[96:111]
    v_perm_b32 v76, v250, v248, s70
    buffer_load_dwordx4 v254, s[32:35], s89 offen lds
    v_perm_b32 v78, v251, v249, s70
    v_perm_b32 v77, v141, v137, s70
    v_mfma_f32_32x32x16_bf16 a[112:127], v[84:87], a[156:159], a[112:127]
    ds_read_b128 a[188:191], v64 offset:0
    v_perm_b32 v79, v143, v139, s70
    s_nop 0
    s_waitcnt vmcnt(24) lgkmcnt(4)
    v_mfma_f32_32x32x16_bf16 a[0:15], v[72:75], a[160:163], a[0:15]
    v_cndmask_b32_dpp v248, v145, v144, vcc row_ror:8 row_mask:0xf bank_mask:0xf
    s_mov_b32 s71, 1605632
    v_mov_b32_dpp v145, v144 row_ror:8 row_mask:0xf bank_mask:0x3
    buffer_load_dwordx4 v[96:99], v2, s[36:39], s71 offen offset:0
    v_cndmask_b32_dpp v249, v147, v146, vcc row_ror:8 row_mask:0xf bank_mask:0xf
    v_mfma_f32_32x32x16_bf16 a[16:31], v[76:79], a[160:163], a[16:31]
    ds_read_b128 a[192:195], v23 offset:0
    v_mov_b32_dpp v147, v146 row_ror:8 row_mask:0xf bank_mask:0x3
    v_cndmask_b32_dpp v250, v149, v148, vcc row_ror:8 row_mask:0xf bank_mask:0xf
    v_mov_b32_dpp v149, v148 row_ror:8 row_mask:0xf bank_mask:0x3
    s_add_u32 m0, s85, 148480
    v_cndmask_b32_dpp v251, v151, v150, vcc row_ror:8 row_mask:0xf bank_mask:0xf
    v_mfma_f32_32x32x16_bf16 a[32:47], v[72:75], a[164:167], a[32:47]
    v_mov_b32_dpp v151, v150 row_ror:8 row_mask:0xf bank_mask:0x3
    s_add_u32 s89, s86, 196736
    v_permlane16_swap_b32 v248, v249
    buffer_load_dwordx4 v3, s[32:35], s89 offen lds
    v_mfma_f32_32x32x16_bf16 a[48:63], v[76:79], a[164:167], a[48:63]
    ds_read_b128 a[196:199], v37 offset:0
    v_permlane16_swap_b32 v145, v147
    v_permlane16_swap_b32 v250, v251
    s_add_u32 m0, s85, 119808
    v_mfma_f32_32x32x16_bf16 a[64:79], v[72:75], a[168:171], a[64:79]
    v_permlane16_swap_b32 v149, v151
    s_add_u32 s89, s86, 82048
    v_perm_b32 v80, v250, v248, s69
    v_perm_b32 v82, v251, v249, s69
    v_mfma_f32_32x32x16_bf16 a[80:95], v[76:79], a[168:171], a[80:95]
    ds_read_b128 a[200:203], v51 offset:0
    buffer_load_dwordx4 v3, s[32:35], s89 offen lds
    v_perm_b32 v81, v149, v145, s69
    v_perm_b32 v83, v151, v147, s69
    v_perm_b32 v84, v250, v248, s70
    v_mfma_f32_32x32x16_bf16 a[96:111], v[72:75], a[172:175], a[96:111]
    s_add_u32 m0, s85, 20480
    v_perm_b32 v86, v251, v249, s70
    v_perm_b32 v85, v149, v145, s70
    buffer_load_dwordx4 v254, s[32:35], s89 offen lds
    v_perm_b32 v87, v151, v147, s70
    v_mfma_f32_32x32x16_bf16 a[112:127], v[76:79], a[172:175], a[112:127]
    ds_read_b128 a[204:207], v65 offset:0
    s_waitcnt vmcnt(26) lgkmcnt(4)
    v_mfma_f32_32x32x16_bf16 a[0:15], v[80:83], a[176:179], a[0:15]
    v_cndmask_b32_dpp v248, v153, v152, vcc row_ror:8 row_mask:0xf bank_mask:0xf
    buffer_load_dwordx4 v[100:103], v2, s[36:39], s71 offen offset:1024
    v_mov_b32_dpp v153, v152 row_ror:8 row_mask:0xf bank_mask:0x3
    v_cndmask_b32_dpp v249, v155, v154, vcc row_ror:8 row_mask:0xf bank_mask:0xf
    v_mfma_f32_32x32x16_bf16 a[16:31], v[84:87], a[176:179], a[16:31]
    ds_read_b128 a[208:211], v24 offset:0
    v_mov_b32_dpp v155, v154 row_ror:8 row_mask:0xf bank_mask:0x3
    v_cndmask_b32_dpp v250, v157, v156, vcc row_ror:8 row_mask:0xf bank_mask:0xf
    v_mov_b32_dpp v157, v156 row_ror:8 row_mask:0xf bank_mask:0x3
    v_cndmask_b32_dpp v251, v159, v158, vcc row_ror:8 row_mask:0xf bank_mask:0xf
    v_mfma_f32_32x32x16_bf16 a[32:47], v[80:83], a[180:183], a[32:47]
    v_mov_b32_dpp v159, v158 row_ror:8 row_mask:0xf bank_mask:0x3
    v_permlane16_swap_b32 v248, v249
    s_add_u32 m0, s85, 152576
    v_mfma_f32_32x32x16_bf16 a[48:63], v[84:87], a[180:183], a[48:63]
    ds_read_b128 a[212:215], v38 offset:0
    v_permlane16_swap_b32 v153, v155
    v_permlane16_swap_b32 v250, v251
    v_mfma_f32_32x32x16_bf16 a[64:79], v[80:83], a[184:187], a[64:79]
    s_add_u32 s89, s86, 213120
    v_permlane16_swap_b32 v157, v159
    v_perm_b32 v72, v250, v248, s69
    v_perm_b32 v74, v251, v249, s69
    v_mfma_f32_32x32x16_bf16 a[80:95], v[84:87], a[184:187], a[80:95]
    ds_read_b128 a[216:219], v52 offset:0
    buffer_load_dwordx4 v3, s[32:35], s89 offen lds
    v_perm_b32 v73, v157, v153, s69
    v_perm_b32 v75, v159, v155, s69
    v_mfma_f32_32x32x16_bf16 a[96:111], v[80:83], a[188:191], a[96:111]
    v_perm_b32 v76, v250, v248, s70
    v_perm_b32 v78, v251, v249, s70
    v_perm_b32 v77, v157, v153, s70
    v_perm_b32 v79, v159, v155, s70
    v_mfma_f32_32x32x16_bf16 a[112:127], v[84:87], a[188:191], a[112:127]
    ds_read_b128 a[220:223], v66 offset:0
    s_waitcnt vmcnt(26) lgkmcnt(4)
    v_mfma_f32_32x32x16_bf16 a[0:15], v[72:75], a[192:195], a[0:15]
    v_cndmask_b32_dpp v248, v161, v160, vcc row_ror:8 row_mask:0xf bank_mask:0xf
    s_mov_b32 s71, 65536
    v_mov_b32_dpp v161, v160 row_ror:8 row_mask:0xf bank_mask:0x3
    buffer_load_dwordx4 v[104:107], v2, s[36:39], s71 offen offset:0
    v_cndmask_b32_dpp v249, v163, v162, vcc row_ror:8 row_mask:0xf bank_mask:0xf
    v_mfma_f32_32x32x16_bf16 a[16:31], v[76:79], a[192:195], a[16:31]
    ds_read_b128 a[224:227], v25 offset:0
    v_mov_b32_dpp v163, v162 row_ror:8 row_mask:0xf bank_mask:0x3
    v_cndmask_b32_dpp v250, v165, v164, vcc row_ror:8 row_mask:0xf bank_mask:0xf
    v_mov_b32_dpp v165, v164 row_ror:8 row_mask:0xf bank_mask:0x3
    s_add_u32 m0, s85, 123904
    v_cndmask_b32_dpp v251, v167, v166, vcc row_ror:8 row_mask:0xf bank_mask:0xf
    v_mfma_f32_32x32x16_bf16 a[32:47], v[72:75], a[196:199], a[32:47]
    v_mov_b32_dpp v167, v166 row_ror:8 row_mask:0xf bank_mask:0x3
    s_add_u32 s89, s86, 98432
    v_permlane16_swap_b32 v248, v249
    buffer_load_dwordx4 v3, s[32:35], s89 offen lds
    v_mfma_f32_32x32x16_bf16 a[48:63], v[76:79], a[196:199], a[48:63]
    ds_read_b128 a[228:231], v39 offset:0
    v_permlane16_swap_b32 v161, v163
    v_permlane16_swap_b32 v250, v251
    s_add_u32 m0, s85, 24576
    v_mfma_f32_32x32x16_bf16 a[64:79], v[72:75], a[200:203], a[64:79]
    v_permlane16_swap_b32 v165, v167
    buffer_load_dwordx4 v254, s[32:35], s89 offen lds
    v_perm_b32 v80, v250, v248, s69
    v_perm_b32 v82, v251, v249, s69
    v_mfma_f32_32x32x16_bf16 a[80:95], v[76:79], a[200:203], a[80:95]
    ds_read_b128 a[232:235], v53 offset:0
    v_perm_b32 v81, v165, v161, s69
    v_perm_b32 v83, v167, v163, s69
    s_add_u32 m0, s85, 156672
    v_perm_b32 v84, v250, v248, s70
    s_add_u32 s89, s86, 229504
    v_mfma_f32_32x32x16_bf16 a[96:111], v[72:75], a[204:207], a[96:111]
    v_perm_b32 v86, v251, v249, s70
    v_perm_b32 v85, v165, v161, s70
    buffer_load_dwordx4 v3, s[32:35], s89 offen lds
    v_perm_b32 v87, v167, v163, s70
    v_mfma_f32_32x32x16_bf16 a[112:127], v[76:79], a[204:207], a[112:127]
    ds_read_b128 a[236:239], v67 offset:0
    s_waitcnt vmcnt(25) lgkmcnt(4)
    v_mfma_f32_32x32x16_bf16 a[0:15], v[80:83], a[208:211], a[0:15]
    v_cndmask_b32_dpp v248, v169, v168, vcc row_ror:8 row_mask:0xf bank_mask:0xf
    buffer_load_dwordx4 v[108:111], v2, s[36:39], s71 offen offset:1024
    v_mov_b32_dpp v169, v168 row_ror:8 row_mask:0xf bank_mask:0x3
    v_cndmask_b32_dpp v249, v171, v170, vcc row_ror:8 row_mask:0xf bank_mask:0xf
    v_mfma_f32_32x32x16_bf16 a[16:31], v[84:87], a[208:211], a[16:31]
    ds_read_b128 a[240:243], v26 offset:0
    v_mov_b32_dpp v171, v170 row_ror:8 row_mask:0xf bank_mask:0x3
    v_cndmask_b32_dpp v250, v173, v172, vcc row_ror:8 row_mask:0xf bank_mask:0xf
    v_mov_b32_dpp v173, v172 row_ror:8 row_mask:0xf bank_mask:0x3
    s_add_u32 m0, s85, 128000
    v_mfma_f32_32x32x16_bf16 a[32:47], v[80:83], a[212:215], a[32:47]
    v_cndmask_b32_dpp v251, v175, v174, vcc row_ror:8 row_mask:0xf bank_mask:0xf
    v_mov_b32_dpp v175, v174 row_ror:8 row_mask:0xf bank_mask:0x3
    v_permlane16_swap_b32 v248, v249
    s_add_u32 s89, s86, 114816
    v_mfma_f32_32x32x16_bf16 a[48:63], v[84:87], a[212:215], a[48:63]
    ds_read_b128 a[244:247], v40 offset:0
    v_permlane16_swap_b32 v169, v171
    buffer_load_dwordx4 v3, s[32:35], s89 offen lds
    v_mfma_f32_32x32x16_bf16 a[64:79], v[80:83], a[216:219], a[64:79]
    v_permlane16_swap_b32 v250, v251
    v_permlane16_swap_b32 v173, v175
    v_perm_b32 v72, v250, v248, s69
    v_mfma_f32_32x32x16_bf16 a[80:95], v[84:87], a[216:219], a[80:95]
    ds_read_b128 a[248:251], v54 offset:0
    v_perm_b32 v74, v251, v249, s69
    s_add_u32 m0, s85, 28672
    v_perm_b32 v73, v173, v169, s69
    v_perm_b32 v75, v175, v171, s69
    v_mfma_f32_32x32x16_bf16 a[96:111], v[80:83], a[220:223], a[96:111]
    v_perm_b32 v76, v250, v248, s70
    buffer_load_dwordx4 v254, s[32:35], s89 offen lds
    v_perm_b32 v78, v251, v249, s70
    v_perm_b32 v77, v173, v169, s70
    v_mfma_f32_32x32x16_bf16 a[112:127], v[84:87], a[220:223], a[112:127]
    ds_read_b128 a[252:255], v68 offset:0
    v_perm_b32 v79, v175, v171, s70
    s_nop 0
    s_waitcnt vmcnt(21) lgkmcnt(4)
    v_mfma_f32_32x32x16_bf16 a[0:15], v[72:75], a[224:227], a[0:15]
    v_cndmask_b32_dpp v248, v177, v176, vcc row_ror:8 row_mask:0xf bank_mask:0xf
    s_mov_b32 s71, 196608
    v_mov_b32_dpp v177, v176 row_ror:8 row_mask:0xf bank_mask:0x3
    v_cndmask_b32_dpp v249, v179, v178, vcc row_ror:8 row_mask:0xf bank_mask:0xf
    v_mov_b32_dpp v179, v178 row_ror:8 row_mask:0xf bank_mask:0x3
    v_mfma_f32_32x32x16_bf16 a[16:31], v[76:79], a[224:227], a[16:31]
    ds_read_b128 a[128:131], v27 offset:0
    buffer_load_dwordx4 v[112:115], v2, s[36:39], s71 offen offset:0
    v_cndmask_b32_dpp v250, v181, v180, vcc row_ror:8 row_mask:0xf bank_mask:0xf
    v_mov_b32_dpp v181, v180 row_ror:8 row_mask:0xf bank_mask:0x3
    v_mfma_f32_32x32x16_bf16 a[32:47], v[72:75], a[228:231], a[32:47]
    v_cndmask_b32_dpp v251, v183, v182, vcc row_ror:8 row_mask:0xf bank_mask:0xf
    v_mov_b32_dpp v183, v182 row_ror:8 row_mask:0xf bank_mask:0x3
    v_permlane16_swap_b32 v248, v249
    v_mfma_f32_32x32x16_bf16 a[48:63], v[76:79], a[228:231], a[48:63]
    ds_read_b128 a[132:135], v41 offset:0
    v_permlane16_swap_b32 v177, v179
    s_add_u32 m0, s87, 160768
    v_mfma_f32_32x32x16_bf16 a[64:79], v[72:75], a[232:235], a[64:79]
    v_permlane16_swap_b32 v250, v251
    v_permlane16_swap_b32 v181, v183
    s_add_u32 s89, s88, 245888
    v_mfma_f32_32x32x16_bf16 a[80:95], v[76:79], a[232:235], a[80:95]
    ds_read_b128 a[136:139], v55 offset:0
    v_perm_b32 v80, v250, v248, s69
    v_perm_b32 v82, v251, v249, s69
    v_perm_b32 v81, v181, v177, s69
    v_perm_b32 v83, v183, v179, s69
    v_mfma_f32_32x32x16_bf16 a[96:111], v[72:75], a[236:239], a[96:111]
    buffer_load_dwordx4 v3, s[32:35], s89 offen lds
    v_perm_b32 v84, v250, v248, s70
    v_perm_b32 v86, v251, v249, s70
    v_perm_b32 v85, v181, v177, s70
    v_mfma_f32_32x32x16_bf16 a[112:127], v[76:79], a[236:239], a[112:127]
    ds_read_b128 a[140:143], v69 offset:0
    v_perm_b32 v87, v183, v179, s70
    s_nop 0
    s_waitcnt vmcnt(17) lgkmcnt(4)
    v_mfma_f32_32x32x16_bf16 a[0:15], v[80:83], a[240:243], a[0:15]
    v_cndmask_b32_dpp v248, v89, v88, vcc row_ror:8 row_mask:0xf bank_mask:0xf
    buffer_load_dwordx4 v[116:119], v2, s[36:39], s71 offen offset:1024
    v_mov_b32_dpp v89, v88 row_ror:8 row_mask:0xf bank_mask:0x3
    v_cndmask_b32_dpp v249, v91, v90, vcc row_ror:8 row_mask:0xf bank_mask:0xf
    v_mfma_f32_32x32x16_bf16 a[16:31], v[84:87], a[240:243], a[16:31]
    ds_read_b128 a[144:147], v28 offset:0
    v_mov_b32_dpp v91, v90 row_ror:8 row_mask:0xf bank_mask:0x3
    v_cndmask_b32_dpp v250, v93, v92, vcc row_ror:8 row_mask:0xf bank_mask:0xf
    v_mov_b32_dpp v93, v92 row_ror:8 row_mask:0xf bank_mask:0x3
    v_cndmask_b32_dpp v251, v95, v94, vcc row_ror:8 row_mask:0xf bank_mask:0xf
    v_mfma_f32_32x32x16_bf16 a[32:47], v[80:83], a[244:247], a[32:47]
    v_mov_b32_dpp v95, v94 row_ror:8 row_mask:0xf bank_mask:0x3
    s_mov_b32 s71, 327680
    v_permlane16_swap_b32 v248, v249
    v_mfma_f32_32x32x16_bf16 a[48:63], v[84:87], a[244:247], a[48:63]
    ds_read_b128 a[148:151], v42 offset:0
    v_permlane16_swap_b32 v89, v91
    buffer_load_dwordx4 v[120:123], v2, s[36:39], s71 offen offset:0
    v_mfma_f32_32x32x16_bf16 a[64:79], v[80:83], a[248:251], a[64:79]
    v_permlane16_swap_b32 v250, v251
    v_permlane16_swap_b32 v93, v95
    v_perm_b32 v72, v250, v248, s69
    v_mfma_f32_32x32x16_bf16 a[80:95], v[84:87], a[248:251], a[80:95]
    ds_read_b128 a[152:155], v56 offset:0
    v_perm_b32 v74, v251, v249, s69
    v_perm_b32 v73, v93, v89, s69
    v_perm_b32 v75, v95, v91, s69
    v_mfma_f32_32x32x16_bf16 a[96:111], v[80:83], a[252:255], a[96:111]
    buffer_load_dwordx4 v[124:127], v2, s[36:39], s71 offen offset:1024
    v_perm_b32 v76, v250, v248, s70
    v_perm_b32 v78, v251, v249, s70
    v_perm_b32 v77, v93, v89, s70
    v_mfma_f32_32x32x16_bf16 a[112:127], v[84:87], a[252:255], a[112:127]
    ds_read_b128 a[156:159], v70 offset:0
    v_perm_b32 v79, v95, v91, s70
    s_nop 0
    s_waitcnt vmcnt(13) lgkmcnt(4)
    v_mfma_f32_32x32x16_bf16 a[0:15], v[72:75], a[128:131], a[0:15]
    v_cndmask_b32_dpp v248, v97, v96, vcc row_ror:8 row_mask:0xf bank_mask:0xf
    s_mov_b32 s71, 458752
    v_mov_b32_dpp v97, v96 row_ror:8 row_mask:0xf bank_mask:0x3
    v_cndmask_b32_dpp v249, v99, v98, vcc row_ror:8 row_mask:0xf bank_mask:0xf
    v_mov_b32_dpp v99, v98 row_ror:8 row_mask:0xf bank_mask:0x3
    v_mfma_f32_32x32x16_bf16 a[16:31], v[76:79], a[128:131], a[16:31]
    buffer_load_dwordx4 v[128:131], v2, s[36:39], s71 offen offset:0
    v_cndmask_b32_dpp v250, v101, v100, vcc row_ror:8 row_mask:0xf bank_mask:0xf
    v_mov_b32_dpp v101, v100 row_ror:8 row_mask:0xf bank_mask:0x3
    v_cndmask_b32_dpp v251, v103, v102, vcc row_ror:8 row_mask:0xf bank_mask:0xf
    v_mfma_f32_32x32x16_bf16 a[32:47], v[72:75], a[132:135], a[32:47]
    v_mov_b32_dpp v103, v102 row_ror:8 row_mask:0xf bank_mask:0x3
    v_permlane16_swap_b32 v248, v249
    v_permlane16_swap_b32 v97, v99
    v_mfma_f32_32x32x16_bf16 a[48:63], v[76:79], a[132:135], a[48:63]
    s_waitcnt vmcnt(4) lgkmcnt(0)
    s_barrier
    ds_read_b128 a[160:163], v16 offset:64512
    buffer_load_dwordx4 v[132:135], v2, s[36:39], s71 offen offset:1024
    v_mfma_f32_32x32x16_bf16 a[64:79], v[72:75], a[136:139], a[64:79]
    ds_read_b128 a[164:167], v30 offset:64512
    v_permlane16_swap_b32 v250, v251
    v_permlane16_swap_b32 v101, v103
    v_mfma_f32_32x32x16_bf16 a[80:95], v[76:79], a[136:139], a[80:95]
    ds_read_b128 a[168:171], v44 offset:64512
    v_perm_b32 v80, v250, v248, s69
    s_mov_b32 s71, 589824
    v_perm_b32 v82, v251, v249, s69
    v_perm_b32 v81, v101, v97, s69
    v_mfma_f32_32x32x16_bf16 a[96:111], v[72:75], a[140:143], a[96:111]
    v_perm_b32 v83, v103, v99, s69
    v_perm_b32 v84, v250, v248, s70
    buffer_load_dwordx4 v[136:139], v2, s[36:39], s71 offen offset:0
    v_perm_b32 v86, v251, v249, s70
    v_mfma_f32_32x32x16_bf16 a[112:127], v[76:79], a[140:143], a[112:127]
    ds_read_b128 a[172:175], v58 offset:64512
    v_perm_b32 v85, v101, v97, s70
    v_perm_b32 v87, v103, v99, s70
    s_nop 0
    v_mfma_f32_32x32x16_bf16 a[0:15], v[80:83], a[144:147], a[0:15]
    v_cndmask_b32_dpp v248, v105, v104, vcc row_ror:8 row_mask:0xf bank_mask:0xf
    buffer_load_dwordx4 v[140:143], v2, s[36:39], s71 offen offset:1024
    v_mov_b32_dpp v105, v104 row_ror:8 row_mask:0xf bank_mask:0x3
    v_cndmask_b32_dpp v249, v107, v106, vcc row_ror:8 row_mask:0xf bank_mask:0xf
    v_mov_b32_dpp v107, v106 row_ror:8 row_mask:0xf bank_mask:0x3
    v_mfma_f32_32x32x16_bf16 a[16:31], v[84:87], a[144:147], a[16:31]
    ds_read_b128 a[176:179], v17 offset:64512
    v_cndmask_b32_dpp v250, v109, v108, vcc row_ror:8 row_mask:0xf bank_mask:0xf
    s_add_u32 m0, s85, 32768
    v_mov_b32_dpp v109, v108 row_ror:8 row_mask:0xf bank_mask:0x3
    v_cndmask_b32_dpp v251, v111, v110, vcc row_ror:8 row_mask:0xf bank_mask:0xf
    v_mov_b32_dpp v111, v110 row_ror:8 row_mask:0xf bank_mask:0x3
    v_mfma_f32_32x32x16_bf16 a[32:47], v[80:83], a[148:151], a[32:47]
    s_add_u32 s89, s86, 131200
    v_permlane16_swap_b32 v248, v249
    buffer_load_dwordx4 v254, s[32:35], s89 offen lds
    v_mfma_f32_32x32x16_bf16 a[48:63], v[84:87], a[148:151], a[48:63]
    ds_read_b128 a[180:183], v31 offset:64512
    v_permlane16_swap_b32 v105, v107
    v_permlane16_swap_b32 v250, v251
    v_mfma_f32_32x32x16_bf16 a[64:79], v[80:83], a[152:155], a[64:79]
    v_permlane16_swap_b32 v109, v111
    s_mov_b32 s71, 720896
    v_perm_b32 v72, v250, v248, s69
    buffer_load_dwordx4 v[144:147], v2, s[36:39], s71 offen offset:0
    v_mfma_f32_32x32x16_bf16 a[80:95], v[84:87], a[152:155], a[80:95]
    ds_read_b128 a[184:187], v45 offset:64512
    v_perm_b32 v74, v251, v249, s69
    v_perm_b32 v73, v109, v105, s69
    v_perm_b32 v75, v111, v107, s69
    v_perm_b32 v76, v250, v248, s70
    v_perm_b32 v78, v251, v249, s70
    v_mfma_f32_32x32x16_bf16 a[96:111], v[80:83], a[156:159], a[96:111]
    buffer_load_dwordx4 v[148:151], v2, s[36:39], s71 offen offset:1024
    v_perm_b32 v77, v109, v105, s70
    v_perm_b32 v79, v111, v107, s70
    v_mfma_f32_32x32x16_bf16 a[112:127], v[84:87], a[156:159], a[112:127]
    ds_read_b128 a[188:191], v59 offset:64512
    s_waitcnt vmcnt(9) lgkmcnt(4)
    v_mfma_f32_32x32x16_bf16 a[0:15], v[72:75], a[160:163], a[0:15]
    v_cndmask_b32_dpp v248, v113, v112, vcc row_ror:8 row_mask:0xf bank_mask:0xf
    s_mov_b32 s71, 851968
    v_mov_b32_dpp v113, v112 row_ror:8 row_mask:0xf bank_mask:0x3
    v_cndmask_b32_dpp v249, v115, v114, vcc row_ror:8 row_mask:0xf bank_mask:0xf
    buffer_load_dwordx4 v[152:155], v2, s[36:39], s71 offen offset:0
    v_mfma_f32_32x32x16_bf16 a[16:31], v[76:79], a[160:163], a[16:31]
    ds_read_b128 a[192:195], v18 offset:64512
    v_mov_b32_dpp v115, v114 row_ror:8 row_mask:0xf bank_mask:0x3
    v_cndmask_b32_dpp v250, v117, v116, vcc row_ror:8 row_mask:0xf bank_mask:0xf
    v_mov_b32_dpp v117, v116 row_ror:8 row_mask:0xf bank_mask:0x3
    v_cndmask_b32_dpp v251, v119, v118, vcc row_ror:8 row_mask:0xf bank_mask:0xf
    s_add_u32 m0, s85, 36864
    v_mfma_f32_32x32x16_bf16 a[32:47], v[72:75], a[164:167], a[32:47]
    v_mov_b32_dpp v119, v118 row_ror:8 row_mask:0xf bank_mask:0x3
    v_permlane16_swap_b32 v248, v249
    s_add_u32 s89, s86, 147584
    v_permlane16_swap_b32 v113, v115
    v_mfma_f32_32x32x16_bf16 a[48:63], v[76:79], a[164:167], a[48:63]
    ds_read_b128 a[196:199], v32 offset:64512
    buffer_load_dwordx4 v254, s[32:35], s89 offen lds
    v_permlane16_swap_b32 v250, v251
    v_mfma_f32_32x32x16_bf16 a[64:79], v[72:75], a[168:171], a[64:79]
    v_permlane16_swap_b32 v117, v119
    buffer_load_dwordx4 v[156:159], v2, s[36:39], s71 offen offset:1024
    v_perm_b32 v80, v250, v248, s69
    v_perm_b32 v82, v251, v249, s69
    v_mfma_f32_32x32x16_bf16 a[80:95], v[76:79], a[168:171], a[80:95]
    ds_read_b128 a[200:203], v46 offset:64512
    v_perm_b32 v81, v117, v113, s69
    v_perm_b32 v83, v119, v115, s69
    v_perm_b32 v84, v250, v248, s70
    s_mov_b32 s71, 983040
    v_perm_b32 v86, v251, v249, s70
    v_mfma_f32_32x32x16_bf16 a[96:111], v[72:75], a[172:175], a[96:111]
    v_perm_b32 v85, v117, v113, s70
    buffer_load_dwordx4 v[160:163], v2, s[36:39], s71 offen offset:0
    v_perm_b32 v87, v119, v115, s70
    v_mfma_f32_32x32x16_bf16 a[112:127], v[76:79], a[172:175], a[112:127]
    ds_read_b128 a[204:207], v60 offset:64512
    s_waitcnt vmcnt(11) lgkmcnt(4)
    v_mfma_f32_32x32x16_bf16 a[0:15], v[80:83], a[176:179], a[0:15]
    v_cndmask_b32_dpp v248, v121, v120, vcc row_ror:8 row_mask:0xf bank_mask:0xf
    buffer_load_dwordx4 v[164:167], v2, s[36:39], s71 offen offset:1024
    v_mov_b32_dpp v121, v120 row_ror:8 row_mask:0xf bank_mask:0x3
    v_cndmask_b32_dpp v249, v123, v122, vcc row_ror:8 row_mask:0xf bank_mask:0xf
    v_mov_b32_dpp v123, v122 row_ror:8 row_mask:0xf bank_mask:0x3
    v_mfma_f32_32x32x16_bf16 a[16:31], v[84:87], a[176:179], a[16:31]
    ds_read_b128 a[208:211], v19 offset:64512
    v_cndmask_b32_dpp v250, v125, v124, vcc row_ror:8 row_mask:0xf bank_mask:0xf
    s_add_u32 m0, s85, 40960
    v_mov_b32_dpp v125, v124 row_ror:8 row_mask:0xf bank_mask:0x3
    v_cndmask_b32_dpp v251, v127, v126, vcc row_ror:8 row_mask:0xf bank_mask:0xf
    v_mov_b32_dpp v127, v126 row_ror:8 row_mask:0xf bank_mask:0x3
    v_mfma_f32_32x32x16_bf16 a[32:47], v[80:83], a[180:183], a[32:47]
    s_add_u32 s89, s86, 163968
    v_permlane16_swap_b32 v248, v249
    buffer_load_dwordx4 v254, s[32:35], s89 offen lds
    v_mfma_f32_32x32x16_bf16 a[48:63], v[84:87], a[180:183], a[48:63]
    ds_read_b128 a[212:215], v33 offset:64512
    v_permlane16_swap_b32 v121, v123
    v_permlane16_swap_b32 v250, v251
    v_mfma_f32_32x32x16_bf16 a[64:79], v[80:83], a[184:187], a[64:79]
    v_permlane16_swap_b32 v125, v127
    s_mov_b32 s71, 1114112
    v_perm_b32 v72, v250, v248, s69
    buffer_load_dwordx4 v[168:171], v2, s[36:39], s71 offen offset:0
    v_mfma_f32_32x32x16_bf16 a[80:95], v[84:87], a[184:187], a[80:95]
    ds_read_b128 a[216:219], v47 offset:64512
    v_perm_b32 v74, v251, v249, s69
    v_perm_b32 v73, v125, v121, s69
    v_perm_b32 v75, v127, v123, s69
    v_perm_b32 v76, v250, v248, s70
    v_perm_b32 v78, v251, v249, s70
    v_mfma_f32_32x32x16_bf16 a[96:111], v[80:83], a[188:191], a[96:111]
    buffer_load_dwordx4 v[172:175], v2, s[36:39], s71 offen offset:1024
    v_perm_b32 v77, v125, v121, s70
    v_perm_b32 v79, v127, v123, s70
    v_mfma_f32_32x32x16_bf16 a[112:127], v[84:87], a[188:191], a[112:127]
    ds_read_b128 a[220:223], v61 offset:64512
    s_waitcnt vmcnt(13) lgkmcnt(4)
    v_mfma_f32_32x32x16_bf16 a[0:15], v[72:75], a[192:195], a[0:15]
    v_cndmask_b32_dpp v248, v129, v128, vcc row_ror:8 row_mask:0xf bank_mask:0xf
    s_mov_b32 s71, 1245184
    v_mov_b32_dpp v129, v128 row_ror:8 row_mask:0xf bank_mask:0x3
    v_cndmask_b32_dpp v249, v131, v130, vcc row_ror:8 row_mask:0xf bank_mask:0xf
    buffer_load_dwordx4 v[176:179], v2, s[36:39], s71 offen offset:0
    v_mfma_f32_32x32x16_bf16 a[16:31], v[76:79], a[192:195], a[16:31]
    ds_read_b128 a[224:227], v20 offset:64512
    v_mov_b32_dpp v131, v130 row_ror:8 row_mask:0xf bank_mask:0x3
    v_cndmask_b32_dpp v250, v133, v132, vcc row_ror:8 row_mask:0xf bank_mask:0xf
    v_mov_b32_dpp v133, v132 row_ror:8 row_mask:0xf bank_mask:0x3
    v_cndmask_b32_dpp v251, v135, v134, vcc row_ror:8 row_mask:0xf bank_mask:0xf
    s_add_u32 m0, s85, 45056
    v_mfma_f32_32x32x16_bf16 a[32:47], v[72:75], a[196:199], a[32:47]
    v_mov_b32_dpp v135, v134 row_ror:8 row_mask:0xf bank_mask:0x3
    v_permlane16_swap_b32 v248, v249
    s_add_u32 s89, s86, 180352
    v_permlane16_swap_b32 v129, v131
    v_mfma_f32_32x32x16_bf16 a[48:63], v[76:79], a[196:199], a[48:63]
    ds_read_b128 a[228:231], v34 offset:64512
    buffer_load_dwordx4 v254, s[32:35], s89 offen lds
    v_permlane16_swap_b32 v250, v251
    v_mfma_f32_32x32x16_bf16 a[64:79], v[72:75], a[200:203], a[64:79]
    v_permlane16_swap_b32 v133, v135
    buffer_load_dwordx4 v[180:183], v2, s[36:39], s71 offen offset:1024
    v_perm_b32 v80, v250, v248, s69
    v_perm_b32 v82, v251, v249, s69
    v_mfma_f32_32x32x16_bf16 a[80:95], v[76:79], a[200:203], a[80:95]
    ds_read_b128 a[232:235], v48 offset:64512
    v_perm_b32 v81, v133, v129, s69
    v_perm_b32 v83, v135, v131, s69
    v_perm_b32 v84, v250, v248, s70
    s_mov_b32 s71, 1376256
    v_perm_b32 v86, v251, v249, s70
    v_mfma_f32_32x32x16_bf16 a[96:111], v[72:75], a[204:207], a[96:111]
    v_perm_b32 v85, v133, v129, s70
    buffer_load_dwordx4 v[88:91], v2, s[36:39], s71 offen offset:0
    v_perm_b32 v87, v135, v131, s70
    v_mfma_f32_32x32x16_bf16 a[112:127], v[76:79], a[204:207], a[112:127]
    ds_read_b128 a[236:239], v62 offset:64512
    s_waitcnt vmcnt(15) lgkmcnt(4)
    v_mfma_f32_32x32x16_bf16 a[0:15], v[80:83], a[208:211], a[0:15]
    v_cndmask_b32_dpp v248, v137, v136, vcc row_ror:8 row_mask:0xf bank_mask:0xf
    buffer_load_dwordx4 v[92:95], v2, s[36:39], s71 offen offset:1024
    v_mov_b32_dpp v137, v136 row_ror:8 row_mask:0xf bank_mask:0x3
    v_cndmask_b32_dpp v249, v139, v138, vcc row_ror:8 row_mask:0xf bank_mask:0xf
    v_mov_b32_dpp v139, v138 row_ror:8 row_mask:0xf bank_mask:0x3
    v_mfma_f32_32x32x16_bf16 a[16:31], v[84:87], a[208:211], a[16:31]
    ds_read_b128 a[240:243], v21 offset:64512
    s_add_u32 m0, s85, 49152
    v_cndmask_b32_dpp v250, v141, v140, vcc row_ror:8 row_mask:0xf bank_mask:0xf
    v_mov_b32_dpp v141, v140 row_ror:8 row_mask:0xf bank_mask:0x3
    s_add_u32 s89, s86, 196736
    v_cndmask_b32_dpp v251, v143, v142, vcc row_ror:8 row_mask:0xf bank_mask:0xf
    v_mfma_f32_32x32x16_bf16 a[32:47], v[80:83], a[212:215], a[32:47]
    v_mov_b32_dpp v143, v142 row_ror:8 row_mask:0xf bank_mask:0x3
    buffer_load_dwordx4 v254, s[32:35], s89 offen lds
    v_permlane16_swap_b32 v248, v249
    v_mfma_f32_32x32x16_bf16 a[48:63], v[84:87], a[212:215], a[48:63]
    ds_read_b128 a[244:247], v35 offset:64512
    v_permlane16_swap_b32 v137, v139
    s_mov_b32 s71, 1507328
    v_permlane16_swap_b32 v250, v251
    v_mfma_f32_32x32x16_bf16 a[64:79], v[80:83], a[216:219], a[64:79]
    buffer_load_dwordx4 v[96:99], v2, s[36:39], s71 offen offset:0
    v_permlane16_swap_b32 v141, v143
    v_perm_b32 v72, v250, v248, s69
    v_subrev_u32 v16, s68, v16
    v_mfma_f32_32x32x16_bf16 a[80:95], v[84:87], a[216:219], a[80:95]
    ds_read_b128 a[248:251], v49 offset:64512
    v_perm_b32 v74, v251, v249, s69
    v_subrev_u32 v30, s68, v30
    v_perm_b32 v73, v141, v137, s69
    v_perm_b32 v75, v143, v139, s69
    v_subrev_u32 v44, s68, v44
    v_mfma_f32_32x32x16_bf16 a[96:111], v[80:83], a[220:223], a[96:111]
    v_perm_b32 v76, v250, v248, s70
    v_perm_b32 v78, v251, v249, s70
    v_subrev_u32 v58, s68, v58
    v_perm_b32 v77, v141, v137, s70
    v_perm_b32 v79, v143, v139, s70
    v_mfma_f32_32x32x16_bf16 a[112:127], v[84:87], a[220:223], a[112:127]
    ds_read_b128 a[252:255], v63 offset:64512
    buffer_load_dwordx4 v[100:103], v2, s[36:39], s71 offen offset:1024
    s_waitcnt vmcnt(16) lgkmcnt(4)
    v_mfma_f32_32x32x16_bf16 a[0:15], v[72:75], a[224:227], a[0:15]
    v_cndmask_b32_dpp v248, v145, v144, vcc row_ror:8 row_mask:0xf bank_mask:0xf
    s_mov_b32 s71, 1638400
    v_mov_b32_dpp v145, v144 row_ror:8 row_mask:0xf bank_mask:0x3
    buffer_load_dwordx4 v[104:107], v2, s[36:39], s71 offen offset:0
    v_cndmask_b32_dpp v249, v147, v146, vcc row_ror:8 row_mask:0xf bank_mask:0xf
    v_mfma_f32_32x32x16_bf16 a[16:31], v[76:79], a[224:227], a[16:31]
    ds_read_b128 a[128:131], v22 offset:64512
    v_mov_b32_dpp v147, v146 row_ror:8 row_mask:0xf bank_mask:0x3
    v_cndmask_b32_dpp v250, v149, v148, vcc row_ror:8 row_mask:0xf bank_mask:0xf
    v_mov_b32_dpp v149, v148 row_ror:8 row_mask:0xf bank_mask:0x3
    s_add_u32 m0, s85, 53248
    v_cndmask_b32_dpp v251, v151, v150, vcc row_ror:8 row_mask:0xf bank_mask:0xf
    v_mfma_f32_32x32x16_bf16 a[32:47], v[72:75], a[228:231], a[32:47]
    s_add_u32 s89, s86, 213120
    v_mov_b32_dpp v151, v150 row_ror:8 row_mask:0xf bank_mask:0x3
    v_permlane16_swap_b32 v248, v249
    buffer_load_dwordx4 v254, s[32:35], s89 offen lds
    v_mfma_f32_32x32x16_bf16 a[48:63], v[76:79], a[228:231], a[48:63]
    ds_read_b128 a[132:135], v36 offset:64512
    v_permlane16_swap_b32 v145, v147
    buffer_load_dwordx4 v[108:111], v2, s[36:39], s71 offen offset:1024
    v_mfma_f32_32x32x16_bf16 a[64:79], v[72:75], a[232:235], a[64:79]
    v_permlane16_swap_b32 v250, v251
    v_permlane16_swap_b32 v149, v151
    v_subrev_u32 v17, s68, v17
    v_perm_b32 v80, v250, v248, s69
    v_mfma_f32_32x32x16_bf16 a[80:95], v[76:79], a[232:235], a[80:95]
    ds_read_b128 a[136:139], v50 offset:64512
    v_subrev_u32 v31, s68, v31
    v_perm_b32 v82, v251, v249, s69
    v_perm_b32 v81, v149, v145, s69
    v_subrev_u32 v45, s68, v45
    v_perm_b32 v83, v151, v147, s69
    v_mfma_f32_32x32x16_bf16 a[96:111], v[72:75], a[236:239], a[96:111]
    v_perm_b32 v84, v250, v248, s70
    v_subrev_u32 v59, s68, v59
    v_perm_b32 v86, v251, v249, s70
    s_mov_b32 s71, 98304
    v_perm_b32 v85, v149, v145, s70
    v_perm_b32 v87, v151, v147, s70
    v_mfma_f32_32x32x16_bf16 a[112:127], v[76:79], a[236:239], a[112:127]
    ds_read_b128 a[140:143], v64 offset:64512
    buffer_load_dwordx4 v[112:115], v2, s[36:39], s71 offen offset:0
    s_waitcnt vmcnt(17) lgkmcnt(4)
    v_mfma_f32_32x32x16_bf16 a[0:15], v[80:83], a[240:243], a[0:15]
    v_cndmask_b32_dpp v248, v153, v152, vcc row_ror:8 row_mask:0xf bank_mask:0xf
    buffer_load_dwordx4 v[116:119], v2, s[36:39], s71 offen offset:1024
    v_mov_b32_dpp v153, v152 row_ror:8 row_mask:0xf bank_mask:0x3
    v_cndmask_b32_dpp v249, v155, v154, vcc row_ror:8 row_mask:0xf bank_mask:0xf
    v_mov_b32_dpp v155, v154 row_ror:8 row_mask:0xf bank_mask:0x3
    v_mfma_f32_32x32x16_bf16 a[16:31], v[84:87], a[240:243], a[16:31]
    ds_read_b128 a[144:147], v23 offset:64512
    s_add_u32 m0, s85, 57344
    v_cndmask_b32_dpp v250, v157, v156, vcc row_ror:8 row_mask:0xf bank_mask:0xf
    v_mov_b32_dpp v157, v156 row_ror:8 row_mask:0xf bank_mask:0x3
    s_add_u32 s89, s86, 229504
    v_cndmask_b32_dpp v251, v159, v158, vcc row_ror:8 row_mask:0xf bank_mask:0xf
    v_mfma_f32_32x32x16_bf16 a[32:47], v[80:83], a[244:247], a[32:47]
    v_mov_b32_dpp v159, v158 row_ror:8 row_mask:0xf bank_mask:0x3
    buffer_load_dwordx4 v254, s[32:35], s89 offen lds
    v_permlane16_swap_b32 v248, v249
    v_mfma_f32_32x32x16_bf16 a[48:63], v[84:87], a[244:247], a[48:63]
    ds_read_b128 a[148:151], v37 offset:64512
    v_permlane16_swap_b32 v153, v155
    s_mov_b32 s71, 229376
    v_permlane16_swap_b32 v250, v251
    v_mfma_f32_32x32x16_bf16 a[64:79], v[80:83], a[248:251], a[64:79]
    buffer_load_dwordx4 v[120:123], v2, s[36:39], s71 offen offset:0
    v_permlane16_swap_b32 v157, v159
    v_perm_b32 v72, v250, v248, s69
    v_subrev_u32 v18, s68, v18
    v_mfma_f32_32x32x16_bf16 a[80:95], v[84:87], a[248:251], a[80:95]
    ds_read_b128 a[152:155], v51 offset:64512
    v_perm_b32 v74, v251, v249, s69
    v_subrev_u32 v32, s68, v32
    v_perm_b32 v73, v157, v153, s69
    v_perm_b32 v75, v159, v155, s69
    v_subrev_u32 v46, s68, v46
    v_mfma_f32_32x32x16_bf16 a[96:111], v[80:83], a[252:255], a[96:111]
    v_perm_b32 v76, v250, v248, s70
    v_perm_b32 v78, v251, v249, s70
    v_subrev_u32 v60, s68, v60
    v_perm_b32 v77, v157, v153, s70
    v_perm_b32 v79, v159, v155, s70
    v_mfma_f32_32x32x16_bf16 a[112:127], v[84:87], a[252:255], a[112:127]
    ds_read_b128 a[156:159], v65 offset:64512
    buffer_load_dwordx4 v[124:127], v2, s[36:39], s71 offen offset:1024
    s_waitcnt vmcnt(19) lgkmcnt(4)
    v_mfma_f32_32x32x16_bf16 a[0:15], v[72:75], a[128:131], a[0:15]
    v_cndmask_b32_dpp v248, v161, v160, vcc row_ror:8 row_mask:0xf bank_mask:0xf
    s_mov_b32 s71, 360448
    v_mov_b32_dpp v161, v160 row_ror:8 row_mask:0xf bank_mask:0x3
    buffer_load_dwordx4 v[128:131], v2, s[36:39], s71 offen offset:0
    v_cndmask_b32_dpp v249, v163, v162, vcc row_ror:8 row_mask:0xf bank_mask:0xf
    v_mfma_f32_32x32x16_bf16 a[16:31], v[76:79], a[128:131], a[16:31]
    ds_read_b128 a[160:163], v24 offset:64512
    v_mov_b32_dpp v163, v162 row_ror:8 row_mask:0xf bank_mask:0x3
    v_cndmask_b32_dpp v250, v165, v164, vcc row_ror:8 row_mask:0xf bank_mask:0xf
    v_mov_b32_dpp v165, v164 row_ror:8 row_mask:0xf bank_mask:0x3
    s_add_u32 m0, s87, 61440
    v_cndmask_b32_dpp v251, v167, v166, vcc row_ror:8 row_mask:0xf bank_mask:0xf
    v_mfma_f32_32x32x16_bf16 a[32:47], v[72:75], a[132:135], a[32:47]
    s_add_u32 s89, s88, 245888
    v_mov_b32_dpp v167, v166 row_ror:8 row_mask:0xf bank_mask:0x3
    v_permlane16_swap_b32 v248, v249
    buffer_load_dwordx4 v254, s[32:35], s89 offen lds
    v_mfma_f32_32x32x16_bf16 a[48:63], v[76:79], a[132:135], a[48:63]
    ds_read_b128 a[164:167], v38 offset:64512
    v_permlane16_swap_b32 v161, v163
    buffer_load_dwordx4 v[132:135], v2, s[36:39], s71 offen offset:1024
    v_mfma_f32_32x32x16_bf16 a[64:79], v[72:75], a[136:139], a[64:79]
    v_permlane16_swap_b32 v250, v251
    v_permlane16_swap_b32 v165, v167
    v_subrev_u32 v19, s68, v19
    v_perm_b32 v80, v250, v248, s69
    v_mfma_f32_32x32x16_bf16 a[80:95], v[76:79], a[136:139], a[80:95]
    ds_read_b128 a[168:171], v52 offset:64512
    v_subrev_u32 v33, s68, v33
    v_perm_b32 v82, v251, v249, s69
    v_perm_b32 v81, v165, v161, s69
    v_subrev_u32 v47, s68, v47
    v_perm_b32 v83, v167, v163, s69
    v_mfma_f32_32x32x16_bf16 a[96:111], v[72:75], a[140:143], a[96:111]
    v_perm_b32 v84, v250, v248, s70
    v_subrev_u32 v61, s68, v61
    v_perm_b32 v86, v251, v249, s70
    s_mov_b32 s71, 491520
    v_perm_b32 v85, v165, v161, s70
    v_perm_b32 v87, v167, v163, s70
    v_mfma_f32_32x32x16_bf16 a[112:127], v[76:79], a[140:143], a[112:127]
    ds_read_b128 a[172:175], v66 offset:64512
    buffer_load_dwordx4 v[136:139], v2, s[36:39], s71 offen offset:0
    s_waitcnt vmcnt(20) lgkmcnt(4)
    v_mfma_f32_32x32x16_bf16 a[0:15], v[80:83], a[144:147], a[0:15]
    v_cndmask_b32_dpp v248, v169, v168, vcc row_ror:8 row_mask:0xf bank_mask:0xf
    buffer_load_dwordx4 v[140:143], v2, s[36:39], s71 offen offset:1024
    v_mov_b32_dpp v169, v168 row_ror:8 row_mask:0xf bank_mask:0x3
    v_cndmask_b32_dpp v249, v171, v170, vcc row_ror:8 row_mask:0xf bank_mask:0xf
    v_mov_b32_dpp v171, v170 row_ror:8 row_mask:0xf bank_mask:0x3
    v_mfma_f32_32x32x16_bf16 a[16:31], v[84:87], a[144:147], a[16:31]
    ds_read_b128 a[176:179], v25 offset:64512
    v_cndmask_b32_dpp v250, v173, v172, vcc row_ror:8 row_mask:0xf bank_mask:0xf
    v_subrev_u32 v20, s68, v20
    v_mov_b32_dpp v173, v172 row_ror:8 row_mask:0xf bank_mask:0x3
    v_cndmask_b32_dpp v251, v175, v174, vcc row_ror:8 row_mask:0xf bank_mask:0xf
    v_mov_b32_dpp v175, v174 row_ror:8 row_mask:0xf bank_mask:0x3
    v_mfma_f32_32x32x16_bf16 a[32:47], v[80:83], a[148:151], a[32:47]
    v_subrev_u32 v34, s68, v34
    v_permlane16_swap_b32 v248, v249
    v_subrev_u32 v48, s68, v48
    v_permlane16_swap_b32 v169, v171
    v_mfma_f32_32x32x16_bf16 a[48:63], v[84:87], a[148:151], a[48:63]
    ds_read_b128 a[180:183], v39 offset:64512
    v_permlane16_swap_b32 v250, v251
    v_subrev_u32 v62, s68, v62
    v_permlane16_swap_b32 v173, v175
    v_mfma_f32_32x32x16_bf16 a[64:79], v[80:83], a[152:155], a[64:79]
    s_mov_b32 s71, 622592
    v_perm_b32 v72, v250, v248, s69
    buffer_load_dwordx4 v[144:147], v2, s[36:39], s71 offen offset:0
    v_perm_b32 v74, v251, v249, s69
    v_perm_b32 v73, v173, v169, s69
    v_mfma_f32_32x32x16_bf16 a[80:95], v[84:87], a[152:155], a[80:95]
    ds_read_b128 a[184:187], v53 offset:64512
    v_perm_b32 v75, v175, v171, s69
    v_perm_b32 v76, v250, v248, s70
    v_perm_b32 v78, v251, v249, s70
    buffer_load_dwordx4 v[148:151], v2, s[36:39], s71 offen offset:1024
    v_mfma_f32_32x32x16_bf16 a[96:111], v[80:83], a[156:159], a[96:111]
    v_perm_b32 v77, v173, v169, s70
    v_perm_b32 v79, v175, v171, s70
    v_mfma_f32_32x32x16_bf16 a[112:127], v[84:87], a[156:159], a[112:127]
    ds_read_b128 a[188:191], v67 offset:64512
    s_waitcnt vmcnt(20) lgkmcnt(4)
    v_mfma_f32_32x32x16_bf16 a[0:15], v[72:75], a[160:163], a[0:15]
    v_cndmask_b32_dpp v248, v177, v176, vcc row_ror:8 row_mask:0xf bank_mask:0xf
    s_mov_b32 s71, 753664
    v_mov_b32_dpp v177, v176 row_ror:8 row_mask:0xf bank_mask:0x3
    v_cndmask_b32_dpp v249, v179, v178, vcc row_ror:8 row_mask:0xf bank_mask:0xf
    buffer_load_dwordx4 v[152:155], v2, s[36:39], s71 offen offset:0
    v_mfma_f32_32x32x16_bf16 a[16:31], v[76:79], a[160:163], a[16:31]
    ds_read_b128 a[192:195], v26 offset:64512
    v_mov_b32_dpp v179, v178 row_ror:8 row_mask:0xf bank_mask:0x3
    v_cndmask_b32_dpp v250, v181, v180, vcc row_ror:8 row_mask:0xf bank_mask:0xf
    v_mov_b32_dpp v181, v180 row_ror:8 row_mask:0xf bank_mask:0x3
    v_cndmask_b32_dpp v251, v183, v182, vcc row_ror:8 row_mask:0xf bank_mask:0xf
    v_subrev_u32 v21, s68, v21
    v_mfma_f32_32x32x16_bf16 a[32:47], v[72:75], a[164:167], a[32:47]
    v_mov_b32_dpp v183, v182 row_ror:8 row_mask:0xf bank_mask:0x3
    v_permlane16_swap_b32 v248, v249
    v_subrev_u32 v35, s68, v35
    v_permlane16_swap_b32 v177, v179
    v_mfma_f32_32x32x16_bf16 a[48:63], v[76:79], a[164:167], a[48:63]
    ds_read_b128 a[196:199], v40 offset:64512
    v_subrev_u32 v49, s68, v49
    v_permlane16_swap_b32 v250, v251
    v_subrev_u32 v63, s68, v63
    v_mfma_f32_32x32x16_bf16 a[64:79], v[72:75], a[168:171], a[64:79]
    v_permlane16_swap_b32 v181, v183
    buffer_load_dwordx4 v[156:159], v2, s[36:39], s71 offen offset:1024
    v_perm_b32 v80, v250, v248, s69
    v_perm_b32 v82, v251, v249, s69
    v_mfma_f32_32x32x16_bf16 a[80:95], v[76:79], a[168:171], a[80:95]
    ds_read_b128 a[200:203], v54 offset:64512
    v_perm_b32 v81, v181, v177, s69
    v_perm_b32 v83, v183, v179, s69
    v_perm_b32 v84, v250, v248, s70
    s_mov_b32 s71, 884736
    v_perm_b32 v86, v251, v249, s70
    v_mfma_f32_32x32x16_bf16 a[96:111], v[72:75], a[172:175], a[96:111]
    v_perm_b32 v85, v181, v177, s70
    buffer_load_dwordx4 v[160:163], v2, s[36:39], s71 offen offset:0
    v_perm_b32 v87, v183, v179, s70
    v_mfma_f32_32x32x16_bf16 a[112:127], v[76:79], a[172:175], a[112:127]
    ds_read_b128 a[204:207], v68 offset:64512
    s_waitcnt vmcnt(21) lgkmcnt(4)
    v_mfma_f32_32x32x16_bf16 a[0:15], v[80:83], a[176:179], a[0:15]
    v_cndmask_b32_dpp v248, v89, v88, vcc row_ror:8 row_mask:0xf bank_mask:0xf
    buffer_load_dwordx4 v[164:167], v2, s[36:39], s71 offen offset:1024
    v_mov_b32_dpp v89, v88 row_ror:8 row_mask:0xf bank_mask:0x3
    v_cndmask_b32_dpp v249, v91, v90, vcc row_ror:8 row_mask:0xf bank_mask:0xf
    v_mov_b32_dpp v91, v90 row_ror:8 row_mask:0xf bank_mask:0x3
    v_mfma_f32_32x32x16_bf16 a[16:31], v[84:87], a[176:179], a[16:31]
    ds_read_b128 a[208:211], v27 offset:64512
    v_cndmask_b32_dpp v250, v93, v92, vcc row_ror:8 row_mask:0xf bank_mask:0xf
    v_subrev_u32 v22, s68, v22
    v_mov_b32_dpp v93, v92 row_ror:8 row_mask:0xf bank_mask:0x3
    v_cndmask_b32_dpp v251, v95, v94, vcc row_ror:8 row_mask:0xf bank_mask:0xf
    v_mov_b32_dpp v95, v94 row_ror:8 row_mask:0xf bank_mask:0x3
    v_mfma_f32_32x32x16_bf16 a[32:47], v[80:83], a[180:183], a[32:47]
    v_subrev_u32 v36, s68, v36
    v_permlane16_swap_b32 v248, v249
    v_subrev_u32 v50, s68, v50
    v_permlane16_swap_b32 v89, v91
    v_mfma_f32_32x32x16_bf16 a[48:63], v[84:87], a[180:183], a[48:63]
    ds_read_b128 a[212:215], v41 offset:64512
    v_permlane16_swap_b32 v250, v251
    v_subrev_u32 v64, s68, v64
    v_permlane16_swap_b32 v93, v95
    v_mfma_f32_32x32x16_bf16 a[64:79], v[80:83], a[184:187], a[64:79]
    s_mov_b32 s71, 1015808
    v_perm_b32 v72, v250, v248, s69
    buffer_load_dwordx4 v[168:171], v2, s[36:39], s71 offen offset:0
    v_perm_b32 v74, v251, v249, s69
    v_perm_b32 v73, v93, v89, s69
    v_mfma_f32_32x32x16_bf16 a[80:95], v[84:87], a[184:187], a[80:95]
    ds_read_b128 a[216:219], v55 offset:64512
    v_perm_b32 v75, v95, v91, s69
    v_perm_b32 v76, v250, v248, s70
    v_perm_b32 v78, v251, v249, s70
    buffer_load_dwordx4 v[172:175], v2, s[36:39], s71 offen offset:1024
    v_mfma_f32_32x32x16_bf16 a[96:111], v[80:83], a[188:191], a[96:111]
    v_perm_b32 v77, v93, v89, s70
    v_perm_b32 v79, v95, v91, s70
    v_mfma_f32_32x32x16_bf16 a[112:127], v[84:87], a[188:191], a[112:127]
    ds_read_b128 a[220:223], v69 offset:64512
    s_waitcnt vmcnt(21) lgkmcnt(4)
    v_mfma_f32_32x32x16_bf16 a[0:15], v[72:75], a[192:195], a[0:15]
    v_cndmask_b32_dpp v248, v97, v96, vcc row_ror:8 row_mask:0xf bank_mask:0xf
    s_mov_b32 s71, 1146880
    v_mov_b32_dpp v97, v96 row_ror:8 row_mask:0xf bank_mask:0x3
    v_cndmask_b32_dpp v249, v99, v98, vcc row_ror:8 row_mask:0xf bank_mask:0xf
    v_mov_b32_dpp v99, v98 row_ror:8 row_mask:0xf bank_mask:0x3
    v_mfma_f32_32x32x16_bf16 a[16:31], v[76:79], a[192:195], a[16:31]
    ds_read_b128 a[224:227], v28 offset:64512
    buffer_load_dwordx4 v[176:179], v2, s[36:39], s71 offen offset:0
    v_cndmask_b32_dpp v250, v101, v100, vcc row_ror:8 row_mask:0xf bank_mask:0xf
    v_mov_b32_dpp v101, v100 row_ror:8 row_mask:0xf bank_mask:0x3
    v_cndmask_b32_dpp v251, v103, v102, vcc row_ror:8 row_mask:0xf bank_mask:0xf
    v_mfma_f32_32x32x16_bf16 a[32:47], v[72:75], a[196:199], a[32:47]
    v_mov_b32_dpp v103, v102 row_ror:8 row_mask:0xf bank_mask:0x3
    v_permlane16_swap_b32 v248, v249
    v_permlane16_swap_b32 v97, v99
    v_subrev_u32 v23, s68, v23
    v_mfma_f32_32x32x16_bf16 a[48:63], v[76:79], a[196:199], a[48:63]
    ds_read_b128 a[228:231], v42 offset:64512
    v_permlane16_swap_b32 v250, v251
    v_subrev_u32 v37, s68, v37
    v_permlane16_swap_b32 v101, v103
    v_mfma_f32_32x32x16_bf16 a[64:79], v[72:75], a[200:203], a[64:79]
    v_perm_b32 v80, v250, v248, s69
    v_perm_b32 v82, v251, v249, s69
    v_subrev_u32 v51, s68, v51
    v_perm_b32 v81, v101, v97, s69
    v_perm_b32 v83, v103, v99, s69
    v_perm_b32 v84, v250, v248, s70
    v_mfma_f32_32x32x16_bf16 a[80:95], v[76:79], a[200:203], a[80:95]
    ds_read_b128 a[232:235], v56 offset:64512
    v_subrev_u32 v65, s68, v65
    v_perm_b32 v86, v251, v249, s70
    v_perm_b32 v85, v101, v97, s70
    v_perm_b32 v87, v103, v99, s70
    s_waitcnt vmcnt(19)
    v_cndmask_b32_dpp v248, v105, v104, vcc row_ror:8 row_mask:0xf bank_mask:0xf
    v_mfma_f32_32x32x16_bf16 a[96:111], v[72:75], a[204:207], a[96:111]
    buffer_load_dwordx4 v[180:183], v2, s[36:39], s71 offen offset:1024
    v_mov_b32_dpp v105, v104 row_ror:8 row_mask:0xf bank_mask:0x3
    v_cndmask_b32_dpp v249, v107, v106, vcc row_ror:8 row_mask:0xf bank_mask:0xf
    v_mov_b32_dpp v107, v106 row_ror:8 row_mask:0xf bank_mask:0x3
    v_mfma_f32_32x32x16_bf16 a[112:127], v[76:79], a[204:207], a[112:127]
    ds_read_b128 a[236:239], v70 offset:64512
    s_waitcnt lgkmcnt(4)
    v_mfma_f32_32x32x16_bf16 a[0:15], v[80:83], a[208:211], a[0:15]
    v_cndmask_b32_dpp v250, v109, v108, vcc row_ror:8 row_mask:0xf bank_mask:0xf
    s_mov_b32 s71, 1277952
    v_mov_b32_dpp v109, v108 row_ror:8 row_mask:0xf bank_mask:0x3
    v_cndmask_b32_dpp v251, v111, v110, vcc row_ror:8 row_mask:0xf bank_mask:0xf
    v_mov_b32_dpp v111, v110 row_ror:8 row_mask:0xf bank_mask:0x3
    v_mfma_f32_32x32x16_bf16 a[16:31], v[84:87], a[208:211], a[16:31]
    buffer_load_dwordx4 v[88:91], v2, s[36:39], s71 offen offset:0
    v_permlane16_swap_b32 v248, v249
    v_permlane16_swap_b32 v105, v107
    v_mfma_f32_32x32x16_bf16 a[32:47], v[80:83], a[212:215], a[32:47]
    v_permlane16_swap_b32 v250, v251
    v_permlane16_swap_b32 v109, v111
    v_subrev_u32 v24, s68, v24
    v_perm_b32 v72, v250, v248, s69
    v_mfma_f32_32x32x16_bf16 a[48:63], v[84:87], a[212:215], a[48:63]
    s_waitcnt vmcnt(14) lgkmcnt(0)
    s_barrier
    ds_read_b128 a[240:243], v16 offset:0
    v_perm_b32 v74, v251, v249, s69
    v_subrev_u32 v38, s68, v38
    v_perm_b32 v73, v109, v105, s69
    v_mfma_f32_32x32x16_bf16 a[64:79], v[80:83], a[216:219], a[64:79]
    ds_read_b128 a[244:247], v30 offset:0
    v_perm_b32 v75, v111, v107, s69
    v_perm_b32 v76, v250, v248, s70
    v_perm_b32 v78, v251, v249, s70
    v_subrev_u32 v52, s68, v52
    v_perm_b32 v77, v109, v105, s70
    v_mfma_f32_32x32x16_bf16 a[80:95], v[84:87], a[216:219], a[80:95]
    ds_read_b128 a[248:251], v44 offset:0
    v_perm_b32 v79, v111, v107, s70
    v_cndmask_b32_dpp v248, v113, v112, vcc row_ror:8 row_mask:0xf bank_mask:0xf
    v_subrev_u32 v66, s68, v66
    v_mov_b32_dpp v113, v112 row_ror:8 row_mask:0xf bank_mask:0x3
    v_cndmask_b32_dpp v249, v115, v114, vcc row_ror:8 row_mask:0xf bank_mask:0xf
    v_mfma_f32_32x32x16_bf16 a[96:111], v[80:83], a[220:223], a[96:111]
    v_mov_b32_dpp v115, v114 row_ror:8 row_mask:0xf bank_mask:0x3
    v_cndmask_b32_dpp v250, v117, v116, vcc row_ror:8 row_mask:0xf bank_mask:0xf
    buffer_load_dwordx4 v[92:95], v2, s[36:39], s71 offen offset:1024
    v_mov_b32_dpp v117, v116 row_ror:8 row_mask:0xf bank_mask:0x3
    v_cndmask_b32_dpp v251, v119, v118, vcc row_ror:8 row_mask:0xf bank_mask:0xf
    v_mfma_f32_32x32x16_bf16 a[112:127], v[84:87], a[220:223], a[112:127]
    ds_read_b128 a[252:255], v58 offset:0
    v_mov_b32_dpp v119, v118 row_ror:8 row_mask:0xf bank_mask:0x3
    v_mfma_f32_32x32x16_bf16 a[0:15], v[72:75], a[224:227], a[0:15]
    v_permlane16_swap_b32 v248, v249
    s_mov_b32 s71, 1409024
    v_permlane16_swap_b32 v113, v115
    v_mfma_f32_32x32x16_bf16 a[16:31], v[76:79], a[224:227], a[16:31]
    ds_read_b128 a[128:131], v17 offset:0
    buffer_load_dwordx4 v[96:99], v2, s[36:39], s71 offen offset:0
    v_permlane16_swap_b32 v250, v251
    v_mfma_f32_32x32x16_bf16 a[32:47], v[72:75], a[228:231], a[32:47]
    v_permlane16_swap_b32 v117, v119
    v_perm_b32 v80, v250, v248, s69
    v_perm_b32 v82, v251, v249, s69
    v_perm_b32 v81, v117, v113, s69
    v_perm_b32 v83, v119, v115, s69
    v_mfma_f32_32x32x16_bf16 a[48:63], v[76:79], a[228:231], a[48:63]
    ds_read_b128 a[132:135], v31 offset:0
    v_subrev_u32 v25, s68, v25
    v_perm_b32 v84, v250, v248, s70
    v_perm_b32 v86, v251, v249, s70
    v_perm_b32 v85, v117, v113, s70
    v_perm_b32 v87, v119, v115, s70
    v_mfma_f32_32x32x16_bf16 a[64:79], v[72:75], a[232:235], a[64:79]
    v_subrev_u32 v39, s68, v39
    v_cndmask_b32_dpp v248, v121, v120, vcc row_ror:8 row_mask:0xf bank_mask:0xf
    v_mov_b32_dpp v121, v120 row_ror:8 row_mask:0xf bank_mask:0x3
    v_cndmask_b32_dpp v249, v123, v122, vcc row_ror:8 row_mask:0xf bank_mask:0xf
    v_mov_b32_dpp v123, v122 row_ror:8 row_mask:0xf bank_mask:0x3
    v_subrev_u32 v53, s68, v53
    v_mfma_f32_32x32x16_bf16 a[80:95], v[76:79], a[232:235], a[80:95]
    ds_read_b128 a[136:139], v45 offset:0
    v_cndmask_b32_dpp v250, v125, v124, vcc row_ror:8 row_mask:0xf bank_mask:0xf
    v_mov_b32_dpp v125, v124 row_ror:8 row_mask:0xf bank_mask:0x3
    v_cndmask_b32_dpp v251, v127, v126, vcc row_ror:8 row_mask:0xf bank_mask:0xf
    v_mov_b32_dpp v127, v126 row_ror:8 row_mask:0xf bank_mask:0x3
    v_subrev_u32 v67, s68, v67
    v_mfma_f32_32x32x16_bf16 a[96:111], v[72:75], a[236:239], a[96:111]
    v_permlane16_swap_b32 v248, v249
    v_permlane16_swap_b32 v121, v123
    buffer_load_dwordx4 v[100:103], v2, s[36:39], s71 offen offset:1024
    v_mfma_f32_32x32x16_bf16 a[112:127], v[76:79], a[236:239], a[112:127]
    ds_read_b128 a[140:143], v59 offset:0
    v_permlane16_swap_b32 v250, v251
    v_permlane16_swap_b32 v125, v127
    s_waitcnt lgkmcnt(4)
    v_mfma_f32_32x32x16_bf16 a[0:15], v[80:83], a[240:243], a[0:15]
    ds_read_b128 a[144:147], v18 offset:0
    v_perm_b32 v72, v250, v248, s69
    s_mov_b32 s71, 1540096
    v_perm_b32 v74, v251, v249, s69
    v_perm_b32 v73, v125, v121, s69
    v_perm_b32 v75, v127, v123, s69
    v_mfma_f32_32x32x16_bf16 a[16:31], v[84:87], a[240:243], a[16:31]
    ds_read_b128 a[148:151], v32 offset:0
    buffer_load_dwordx4 v[104:107], v2, s[36:39], s71 offen offset:0
    v_perm_b32 v76, v250, v248, s70
    v_perm_b32 v78, v251, v249, s70
    v_perm_b32 v77, v125, v121, s70
    v_mfma_f32_32x32x16_bf16 a[32:47], v[80:83], a[244:247], a[32:47]
    v_perm_b32 v79, v127, v123, s70
    s_waitcnt vmcnt(17)
    v_cndmask_b32_dpp v248, v129, v128, vcc row_ror:8 row_mask:0xf bank_mask:0xf
    v_mov_b32_dpp v129, v128 row_ror:8 row_mask:0xf bank_mask:0x3
    v_cndmask_b32_dpp v249, v131, v130, vcc row_ror:8 row_mask:0xf bank_mask:0xf
    v_subrev_u32 v26, s68, v26
    v_mov_b32_dpp v131, v130 row_ror:8 row_mask:0xf bank_mask:0x3
    v_mfma_f32_32x32x16_bf16 a[48:63], v[84:87], a[244:247], a[48:63]
    ds_read_b128 a[152:155], v46 offset:0
    v_cndmask_b32_dpp v250, v133, v132, vcc row_ror:8 row_mask:0xf bank_mask:0xf
    v_mov_b32_dpp v133, v132 row_ror:8 row_mask:0xf bank_mask:0x3
    v_subrev_u32 v40, s68, v40
    v_cndmask_b32_dpp v251, v135, v134, vcc row_ror:8 row_mask:0xf bank_mask:0xf
    v_mov_b32_dpp v135, v134 row_ror:8 row_mask:0xf bank_mask:0x3
    v_mfma_f32_32x32x16_bf16 a[64:79], v[80:83], a[248:251], a[64:79]
    v_permlane16_swap_b32 v248, v249
    v_subrev_u32 v54, s68, v54
    v_permlane16_swap_b32 v129, v131
    v_mfma_f32_32x32x16_bf16 a[80:95], v[84:87], a[248:251], a[80:95]
    ds_read_b128 a[156:159], v60 offset:0
    v_permlane16_swap_b32 v250, v251
    v_subrev_u32 v68, s68, v68
    v_permlane16_swap_b32 v133, v135
    v_mfma_f32_32x32x16_bf16 a[96:111], v[80:83], a[252:255], a[96:111]
    v_perm_b32 v120, v250, v248, s69
    buffer_load_dwordx4 v[108:111], v2, s[36:39], s71 offen offset:1024
    v_perm_b32 v122, v251, v249, s69
    v_perm_b32 v121, v133, v129, s69
    v_perm_b32 v123, v135, v131, s69
    v_mfma_f32_32x32x16_bf16 a[112:127], v[84:87], a[252:255], a[112:127]
    ds_read_b128 a[160:163], v19 offset:0
    s_waitcnt lgkmcnt(5)
    v_mfma_f32_32x32x16_bf16 a[0:15], v[72:75], a[128:131], a[0:15]
    ds_read_b128 a[164:167], v33 offset:0
    v_perm_b32 v124, v250, v248, s70
    s_mov_b32 s71, 1671168
    v_perm_b32 v126, v251, v249, s70
    v_perm_b32 v125, v133, v129, s70
    v_perm_b32 v127, v135, v131, s70
    v_mfma_f32_32x32x16_bf16 a[16:31], v[76:79], a[128:131], a[16:31]
    ds_read_b128 a[168:171], v47 offset:0
    buffer_load_dwordx4 v[112:115], v2, s[36:39], s71 offen offset:0
    s_waitcnt vmcnt(17)
    v_cndmask_b32_dpp v248, v137, v136, vcc row_ror:8 row_mask:0xf bank_mask:0xf
    v_mov_b32_dpp v137, v136 row_ror:8 row_mask:0xf bank_mask:0x3
    v_cndmask_b32_dpp v249, v139, v138, vcc row_ror:8 row_mask:0xf bank_mask:0xf
    v_mfma_f32_32x32x16_bf16 a[32:47], v[72:75], a[132:135], a[32:47]
    v_mov_b32_dpp v139, v138 row_ror:8 row_mask:0xf bank_mask:0x3
    v_cndmask_b32_dpp v250, v141, v140, vcc row_ror:8 row_mask:0xf bank_mask:0xf
    v_mov_b32_dpp v141, v140 row_ror:8 row_mask:0xf bank_mask:0x3
    v_cndmask_b32_dpp v251, v143, v142, vcc row_ror:8 row_mask:0xf bank_mask:0xf
    v_subrev_u32 v27, s68, v27
    v_mov_b32_dpp v143, v142 row_ror:8 row_mask:0xf bank_mask:0x3
    v_mfma_f32_32x32x16_bf16 a[48:63], v[76:79], a[132:135], a[48:63]
    ds_read_b128 a[172:175], v61 offset:0
    v_permlane16_swap_b32 v248, v249
    v_subrev_u32 v41, s68, v41
    v_permlane16_swap_b32 v137, v139
    v_mfma_f32_32x32x16_bf16 a[64:79], v[72:75], a[136:139], a[64:79]
    v_permlane16_swap_b32 v250, v251
    v_subrev_u32 v55, s68, v55
    v_permlane16_swap_b32 v141, v143
    v_perm_b32 v128, v250, v248, s69
    v_mfma_f32_32x32x16_bf16 a[80:95], v[76:79], a[136:139], a[80:95]
    ds_read_b128 a[176:179], v20 offset:0
    v_subrev_u32 v69, s68, v69
    v_perm_b32 v130, v251, v249, s69
    v_perm_b32 v129, v141, v137, s69
    v_perm_b32 v131, v143, v139, s69
    v_perm_b32 v132, v250, v248, s70
    v_mfma_f32_32x32x16_bf16 a[96:111], v[72:75], a[140:143], a[96:111]
    buffer_load_dwordx4 v[116:119], v2, s[36:39], s71 offen offset:1024
    v_perm_b32 v134, v251, v249, s70
    v_perm_b32 v133, v141, v137, s70
    v_perm_b32 v135, v143, v139, s70
    v_mfma_f32_32x32x16_bf16 a[112:127], v[76:79], a[140:143], a[112:127]
    ds_read_b128 a[180:183], v34 offset:0
    s_waitcnt lgkmcnt(6)
    v_mfma_f32_32x32x16_bf16 a[0:15], v[120:123], a[144:147], a[0:15]
    ds_read_b128 a[184:187], v48 offset:0
    s_waitcnt vmcnt(16)
    v_cndmask_b32_dpp v248, v145, v144, vcc row_ror:8 row_mask:0xf bank_mask:0xf
    v_subrev_u32 v28, s68, v28
    v_mov_b32_dpp v145, v144 row_ror:8 row_mask:0xf bank_mask:0x3
    v_cndmask_b32_dpp v249, v147, v146, vcc row_ror:8 row_mask:0xf bank_mask:0xf
    v_mov_b32_dpp v147, v146 row_ror:8 row_mask:0xf bank_mask:0x3
    v_cndmask_b32_dpp v250, v149, v148, vcc row_ror:8 row_mask:0xf bank_mask:0xf
    v_mfma_f32_32x32x16_bf16 a[16:31], v[124:127], a[144:147], a[16:31]
    ds_read_b128 a[188:191], v62 offset:0
    v_mov_b32_dpp v149, v148 row_ror:8 row_mask:0xf bank_mask:0x3
    v_cndmask_b32_dpp v251, v151, v150, vcc row_ror:8 row_mask:0xf bank_mask:0xf
    v_mov_b32_dpp v151, v150 row_ror:8 row_mask:0xf bank_mask:0x3
    v_permlane16_swap_b32 v248, v249
    v_mfma_f32_32x32x16_bf16 a[32:47], v[120:123], a[148:151], a[32:47]
    v_permlane16_swap_b32 v145, v147
    v_subrev_u32 v42, s68, v42
    v_permlane16_swap_b32 v250, v251
    v_permlane16_swap_b32 v149, v151
    v_mfma_f32_32x32x16_bf16 a[48:63], v[124:127], a[148:151], a[48:63]
    ds_read_b128 a[192:195], v21 offset:0
    v_perm_b32 v136, v250, v248, s69
    v_perm_b32 v138, v251, v249, s69
    v_perm_b32 v137, v149, v145, s69
    v_perm_b32 v139, v151, v147, s69
    v_perm_b32 v140, v250, v248, s70
    v_perm_b32 v142, v251, v249, s70
    v_mfma_f32_32x32x16_bf16 a[64:79], v[120:123], a[152:155], a[64:79]
    v_perm_b32 v141, v149, v145, s70
    v_subrev_u32 v56, s68, v56
    v_perm_b32 v143, v151, v147, s70
    s_waitcnt vmcnt(14)
    v_cndmask_b32_dpp v248, v153, v152, vcc row_ror:8 row_mask:0xf bank_mask:0xf
    v_mov_b32_dpp v153, v152 row_ror:8 row_mask:0xf bank_mask:0x3
    v_cndmask_b32_dpp v249, v155, v154, vcc row_ror:8 row_mask:0xf bank_mask:0xf
    v_mov_b32_dpp v155, v154 row_ror:8 row_mask:0xf bank_mask:0x3
    v_mfma_f32_32x32x16_bf16 a[80:95], v[124:127], a[152:155], a[80:95]
    ds_read_b128 a[196:199], v35 offset:0
    v_cndmask_b32_dpp v250, v157, v156, vcc row_ror:8 row_mask:0xf bank_mask:0xf
    v_mov_b32_dpp v157, v156 row_ror:8 row_mask:0xf bank_mask:0x3
    v_cndmask_b32_dpp v251, v159, v158, vcc row_ror:8 row_mask:0xf bank_mask:0xf
    v_mov_b32_dpp v159, v158 row_ror:8 row_mask:0xf bank_mask:0x3
    v_permlane16_swap_b32 v248, v249
    v_mfma_f32_32x32x16_bf16 a[96:111], v[120:123], a[156:159], a[96:111]
    v_subrev_u32 v70, s68, v70
    v_permlane16_swap_b32 v153, v155
    v_permlane16_swap_b32 v250, v251
    v_permlane16_swap_b32 v157, v159
    v_mfma_f32_32x32x16_bf16 a[112:127], v[124:127], a[156:159], a[112:127]
    ds_read_b128 a[200:203], v49 offset:0
    s_waitcnt lgkmcnt(7)
    v_mfma_f32_32x32x16_bf16 a[0:15], v[128:131], a[160:163], a[0:15]
    ds_read_b128 a[204:207], v63 offset:0
    v_perm_b32 v144, v250, v248, s69
    v_perm_b32 v146, v251, v249, s69
    v_perm_b32 v145, v157, v153, s69
    v_perm_b32 v147, v159, v155, s69
    v_perm_b32 v148, v250, v248, s70
    v_mfma_f32_32x32x16_bf16 a[16:31], v[132:135], a[160:163], a[16:31]
    ds_read_b128 a[208:211], v22 offset:0
    v_perm_b32 v150, v251, v249, s70
    v_perm_b32 v149, v157, v153, s70
    v_perm_b32 v151, v159, v155, s70
    s_waitcnt vmcnt(12)
    v_cndmask_b32_dpp v248, v161, v160, vcc row_ror:8 row_mask:0xf bank_mask:0xf
    v_mov_b32_dpp v161, v160 row_ror:8 row_mask:0xf bank_mask:0x3
    v_mfma_f32_32x32x16_bf16 a[32:47], v[128:131], a[164:167], a[32:47]
    v_cndmask_b32_dpp v249, v163, v162, vcc row_ror:8 row_mask:0xf bank_mask:0xf
    v_mov_b32_dpp v163, v162 row_ror:8 row_mask:0xf bank_mask:0x3
    v_cndmask_b32_dpp v250, v165, v164, vcc row_ror:8 row_mask:0xf bank_mask:0xf
    v_mov_b32_dpp v165, v164 row_ror:8 row_mask:0xf bank_mask:0x3
    v_cndmask_b32_dpp v251, v167, v166, vcc row_ror:8 row_mask:0xf bank_mask:0xf
    v_mov_b32_dpp v167, v166 row_ror:8 row_mask:0xf bank_mask:0x3
    v_mfma_f32_32x32x16_bf16 a[48:63], v[132:135], a[164:167], a[48:63]
    ds_read_b128 a[212:215], v36 offset:0
    v_permlane16_swap_b32 v248, v249
    v_permlane16_swap_b32 v161, v163
    v_mfma_f32_32x32x16_bf16 a[64:79], v[128:131], a[168:171], a[64:79]
    ds_read_b128 a[216:219], v50 offset:0
    v_permlane16_swap_b32 v250, v251
    v_permlane16_swap_b32 v165, v167
    v_perm_b32 v152, v250, v248, s69
    v_mfma_f32_32x32x16_bf16 a[80:95], v[132:135], a[168:171], a[80:95]
    ds_read_b128 a[220:223], v64 offset:0
    v_perm_b32 v154, v251, v249, s69
    v_perm_b32 v153, v165, v161, s69
    v_perm_b32 v155, v167, v163, s69
    v_perm_b32 v156, v250, v248, s70
    v_perm_b32 v158, v251, v249, s70
    v_mfma_f32_32x32x16_bf16 a[96:111], v[128:131], a[172:175], a[96:111]
    v_perm_b32 v157, v165, v161, s70
    v_perm_b32 v159, v167, v163, s70
    s_waitcnt vmcnt(10)
    v_cndmask_b32_dpp v248, v169, v168, vcc row_ror:8 row_mask:0xf bank_mask:0xf
    v_mov_b32_dpp v169, v168 row_ror:8 row_mask:0xf bank_mask:0x3
    v_cndmask_b32_dpp v249, v171, v170, vcc row_ror:8 row_mask:0xf bank_mask:0xf
    v_mov_b32_dpp v171, v170 row_ror:8 row_mask:0xf bank_mask:0x3
    v_mfma_f32_32x32x16_bf16 a[112:127], v[132:135], a[172:175], a[112:127]
    ds_read_b128 a[224:227], v23 offset:0
    s_waitcnt lgkmcnt(9)
    v_mfma_f32_32x32x16_bf16 a[0:15], v[136:139], a[176:179], a[0:15]
    ds_read_b128 a[228:231], v24 offset:0
    v_cndmask_b32_dpp v250, v173, v172, vcc row_ror:8 row_mask:0xf bank_mask:0xf
    v_mov_b32_dpp v173, v172 row_ror:8 row_mask:0xf bank_mask:0x3
    v_cndmask_b32_dpp v251, v175, v174, vcc row_ror:8 row_mask:0xf bank_mask:0xf
    v_mov_b32_dpp v175, v174 row_ror:8 row_mask:0xf bank_mask:0x3
    v_permlane16_swap_b32 v248, v249
    v_mfma_f32_32x32x16_bf16 a[16:31], v[140:143], a[176:179], a[16:31]
    ds_read_b128 a[232:235], v25 offset:0
    v_permlane16_swap_b32 v169, v171
    v_permlane16_swap_b32 v250, v251
    v_permlane16_swap_b32 v173, v175
    v_mfma_f32_32x32x16_bf16 a[32:47], v[136:139], a[180:183], a[32:47]
    v_perm_b32 v160, v250, v248, s69
    v_perm_b32 v162, v251, v249, s69
    v_perm_b32 v161, v173, v169, s69
    v_perm_b32 v163, v175, v171, s69
    v_perm_b32 v164, v250, v248, s70
    v_perm_b32 v166, v251, v249, s70
    v_perm_b32 v165, v173, v169, s70
    v_mfma_f32_32x32x16_bf16 a[48:63], v[140:143], a[180:183], a[48:63]
    ds_read_b128 a[236:239], v26 offset:0
    v_perm_b32 v167, v175, v171, s70
    s_waitcnt vmcnt(8)
    v_cndmask_b32_dpp v248, v177, v176, vcc row_ror:8 row_mask:0xf bank_mask:0xf
    v_mov_b32_dpp v177, v176 row_ror:8 row_mask:0xf bank_mask:0x3
    v_cndmask_b32_dpp v249, v179, v178, vcc row_ror:8 row_mask:0xf bank_mask:0xf
    v_mov_b32_dpp v179, v178 row_ror:8 row_mask:0xf bank_mask:0x3
    v_cndmask_b32_dpp v250, v181, v180, vcc row_ror:8 row_mask:0xf bank_mask:0xf
    v_mfma_f32_32x32x16_bf16 a[64:79], v[136:139], a[184:187], a[64:79]
    ds_read_b128 a[240:243], v27 offset:0
    v_mov_b32_dpp v181, v180 row_ror:8 row_mask:0xf bank_mask:0x3
    v_cndmask_b32_dpp v251, v183, v182, vcc row_ror:8 row_mask:0xf bank_mask:0xf
    v_mov_b32_dpp v183, v182 row_ror:8 row_mask:0xf bank_mask:0x3
    v_permlane16_swap_b32 v248, v249
    v_mfma_f32_32x32x16_bf16 a[80:95], v[140:143], a[184:187], a[80:95]
    ds_read_b128 a[244:247], v28 offset:0
    v_permlane16_swap_b32 v177, v179
    v_permlane16_swap_b32 v250, v251
    v_permlane16_swap_b32 v181, v183
    v_mfma_f32_32x32x16_bf16 a[96:111], v[136:139], a[188:191], a[96:111]
    v_perm_b32 v168, v250, v248, s69
    v_perm_b32 v170, v251, v249, s69
    v_perm_b32 v169, v181, v177, s69
    v_perm_b32 v171, v183, v179, s69
    v_mfma_f32_32x32x16_bf16 a[112:127], v[140:143], a[188:191], a[112:127]
    ds_read_b128 a[248:251], v37 offset:0
    s_waitcnt lgkmcnt(11)
    v_mfma_f32_32x32x16_bf16 a[0:15], v[144:147], a[192:195], a[0:15]
    ds_read_b128 a[252:255], v38 offset:0
    v_perm_b32 v172, v250, v248, s70
    v_perm_b32 v174, v251, v249, s70
    v_perm_b32 v173, v181, v177, s70
    v_perm_b32 v175, v183, v179, s70
    s_waitcnt vmcnt(6)
    v_cndmask_b32_dpp v248, v89, v88, vcc row_ror:8 row_mask:0xf bank_mask:0xf
    v_mfma_f32_32x32x16_bf16 a[16:31], v[148:151], a[192:195], a[16:31]
    ds_read_b128 a[128:131], v39 offset:0
    v_mov_b32_dpp v89, v88 row_ror:8 row_mask:0xf bank_mask:0x3
    v_cndmask_b32_dpp v249, v91, v90, vcc row_ror:8 row_mask:0xf bank_mask:0xf
    v_mov_b32_dpp v91, v90 row_ror:8 row_mask:0xf bank_mask:0x3
    v_cndmask_b32_dpp v250, v93, v92, vcc row_ror:8 row_mask:0xf bank_mask:0xf
    v_mov_b32_dpp v93, v92 row_ror:8 row_mask:0xf bank_mask:0x3
    v_mfma_f32_32x32x16_bf16 a[32:47], v[144:147], a[196:199], a[32:47]
    v_cndmask_b32_dpp v251, v95, v94, vcc row_ror:8 row_mask:0xf bank_mask:0xf
    v_mov_b32_dpp v95, v94 row_ror:8 row_mask:0xf bank_mask:0x3
    v_permlane16_swap_b32 v248, v249
    v_permlane16_swap_b32 v89, v91
    v_mfma_f32_32x32x16_bf16 a[48:63], v[148:151], a[196:199], a[48:63]
    ds_read_b128 a[132:135], v40 offset:0
    v_permlane16_swap_b32 v250, v251
    v_permlane16_swap_b32 v93, v95
    v_perm_b32 v176, v250, v248, s69
    v_mfma_f32_32x32x16_bf16 a[64:79], v[144:147], a[200:203], a[64:79]
    ds_read_b128 a[136:139], v41 offset:0
    v_perm_b32 v178, v251, v249, s69
    v_perm_b32 v177, v93, v89, s69
    v_perm_b32 v179, v95, v91, s69
    v_perm_b32 v180, v250, v248, s70
    v_perm_b32 v182, v251, v249, s70
    v_mfma_f32_32x32x16_bf16 a[80:95], v[148:151], a[200:203], a[80:95]
    ds_read_b128 a[140:143], v42 offset:0
    v_perm_b32 v181, v93, v89, s70
    v_perm_b32 v183, v95, v91, s70
    s_waitcnt vmcnt(4)
    v_cndmask_b32_dpp v248, v97, v96, vcc row_ror:8 row_mask:0xf bank_mask:0xf
    v_mov_b32_dpp v97, v96 row_ror:8 row_mask:0xf bank_mask:0x3
    v_cndmask_b32_dpp v249, v99, v98, vcc row_ror:8 row_mask:0xf bank_mask:0xf
    v_mfma_f32_32x32x16_bf16 a[96:111], v[144:147], a[204:207], a[96:111]
    v_mov_b32_dpp v99, v98 row_ror:8 row_mask:0xf bank_mask:0x3
    v_cndmask_b32_dpp v250, v101, v100, vcc row_ror:8 row_mask:0xf bank_mask:0xf
    v_mov_b32_dpp v101, v100 row_ror:8 row_mask:0xf bank_mask:0x3
    v_cndmask_b32_dpp v251, v103, v102, vcc row_ror:8 row_mask:0xf bank_mask:0xf
    v_mov_b32_dpp v103, v102 row_ror:8 row_mask:0xf bank_mask:0x3
    v_mfma_f32_32x32x16_bf16 a[112:127], v[148:151], a[204:207], a[112:127]
    ds_read_b128 a[144:147], v51 offset:0
    s_waitcnt lgkmcnt(13)
    v_mfma_f32_32x32x16_bf16 a[0:15], v[152:155], a[208:211], a[0:15]
    ds_read_b128 a[148:151], v52 offset:0
    v_permlane16_swap_b32 v248, v249
    v_permlane16_swap_b32 v97, v99
    v_permlane16_swap_b32 v250, v251
    v_mfma_f32_32x32x16_bf16 a[16:31], v[156:159], a[208:211], a[16:31]
    ds_read_b128 a[152:155], v53 offset:0
    v_permlane16_swap_b32 v101, v103
    v_perm_b32 v88, v250, v248, s69
    v_perm_b32 v90, v251, v249, s69
    v_perm_b32 v89, v101, v97, s69
    v_perm_b32 v91, v103, v99, s69
    v_mfma_f32_32x32x16_bf16 a[32:47], v[152:155], a[212:215], a[32:47]
    v_perm_b32 v92, v250, v248, s70
    v_perm_b32 v94, v251, v249, s70
    v_perm_b32 v93, v101, v97, s70
    v_perm_b32 v95, v103, v99, s70
    s_waitcnt vmcnt(2)
    v_cndmask_b32_dpp v248, v105, v104, vcc row_ror:8 row_mask:0xf bank_mask:0xf
    v_mov_b32_dpp v105, v104 row_ror:8 row_mask:0xf bank_mask:0x3
    v_cndmask_b32_dpp v249, v107, v106, vcc row_ror:8 row_mask:0xf bank_mask:0xf
    v_mfma_f32_32x32x16_bf16 a[48:63], v[156:159], a[212:215], a[48:63]
    ds_read_b128 a[156:159], v54 offset:0
    v_mov_b32_dpp v107, v106 row_ror:8 row_mask:0xf bank_mask:0x3
    v_cndmask_b32_dpp v250, v109, v108, vcc row_ror:8 row_mask:0xf bank_mask:0xf
    v_mov_b32_dpp v109, v108 row_ror:8 row_mask:0xf bank_mask:0x3
    v_cndmask_b32_dpp v251, v111, v110, vcc row_ror:8 row_mask:0xf bank_mask:0xf
    v_mov_b32_dpp v111, v110 row_ror:8 row_mask:0xf bank_mask:0x3
    v_mfma_f32_32x32x16_bf16 a[64:79], v[152:155], a[216:219], a[64:79]
    ds_read_b128 a[160:163], v55 offset:0
    v_permlane16_swap_b32 v248, v249
    v_permlane16_swap_b32 v105, v107
    v_permlane16_swap_b32 v250, v251
    v_mfma_f32_32x32x16_bf16 a[80:95], v[156:159], a[216:219], a[80:95]
    ds_read_b128 a[164:167], v56 offset:0
    v_permlane16_swap_b32 v109, v111
    v_perm_b32 v96, v250, v248, s69
    v_perm_b32 v98, v251, v249, s69
    v_perm_b32 v97, v109, v105, s69
    v_perm_b32 v99, v111, v107, s69
    v_mfma_f32_32x32x16_bf16 a[96:111], v[152:155], a[220:223], a[96:111]
    v_perm_b32 v100, v250, v248, s70
    v_perm_b32 v102, v251, v249, s70
    v_perm_b32 v101, v109, v105, s70
    v_perm_b32 v103, v111, v107, s70
    v_mfma_f32_32x32x16_bf16 a[112:127], v[156:159], a[220:223], a[112:127]
    ds_read_b128 a[168:171], v65 offset:0
    s_waitcnt lgkmcnt(15)
    v_mfma_f32_32x32x16_bf16 a[0:15], v[160:163], a[224:227], a[0:15]
    ds_read_b128 a[172:175], v66 offset:0
    s_waitcnt vmcnt(0)
    v_cndmask_b32_dpp v248, v113, v112, vcc row_ror:8 row_mask:0xf bank_mask:0xf
    buffer_load_dword v224, v11, s[56:59], 0 offen sc1
    v_mov_b32_dpp v113, v112 row_ror:8 row_mask:0xf bank_mask:0x3
    v_cndmask_b32_dpp v249, v115, v114, vcc row_ror:8 row_mask:0xf bank_mask:0xf
    v_mov_b32_dpp v115, v114 row_ror:8 row_mask:0xf bank_mask:0x3
    v_mfma_f32_32x32x16_bf16 a[16:31], v[164:167], a[224:227], a[16:31]
    ds_read_b128 a[176:179], v67 offset:0
    v_accvgpr_read_b32 v120, a104
    v_cndmask_b32_dpp v250, v117, v116, vcc row_ror:8 row_mask:0xf bank_mask:0xf
    v_mov_b32_dpp v117, v116 row_ror:8 row_mask:0xf bank_mask:0x3
    v_accvgpr_read_b32 v121, a105
    v_cndmask_b32_dpp v251, v119, v118, vcc row_ror:8 row_mask:0xf bank_mask:0xf
    v_mfma_f32_32x32x16_bf16 a[0:15], v[168:171], a[228:231], a[0:15]
    ds_read_b128 a[180:183], v68 offset:0
    v_mov_b32_dpp v119, v118 row_ror:8 row_mask:0xf bank_mask:0x3
    v_accvgpr_read_b32 v122, a106
    v_permlane16_swap_b32 v248, v249
    v_accvgpr_read_b32 v123, a107
    v_mfma_f32_32x32x16_bf16 a[16:31], v[172:175], a[228:231], a[16:31]
    ds_read_b128 a[184:187], v69 offset:0
    v_permlane16_swap_b32 v113, v115
    v_accvgpr_read_b32 v124, a108
    v_permlane16_swap_b32 v250, v251
    v_mfma_f32_32x32x16_bf16 a[0:15], v[176:179], a[232:235], a[0:15]
    ds_read_b128 a[188:191], v70 offset:0
    v_accvgpr_read_b32 v125, a109
    v_permlane16_swap_b32 v117, v119
    v_accvgpr_read_b32 v126, a110
    v_perm_b32 v104, v250, v248, s69
    v_perm_b32 v106, v251, v249, s69
    v_mfma_f32_32x32x16_bf16 a[16:31], v[180:183], a[232:235], a[16:31]
    v_accvgpr_read_b32 v127, a111
    v_perm_b32 v105, v117, v113, s69
    v_perm_b32 v107, v119, v115, s69
    v_accvgpr_read_b32 v128, a112
    v_perm_b32 v108, v250, v248, s70
    v_accvgpr_read_b32 v129, a113
    v_mfma_f32_32x32x16_bf16 a[0:15], v[88:91], a[236:239], a[0:15]
    v_perm_b32 v110, v251, v249, s70
    v_perm_b32 v109, v117, v113, s70
    v_accvgpr_read_b32 v130, a114
    v_perm_b32 v111, v119, v115, s70
    v_accvgpr_read_b32 v131, a115
    v_mfma_f32_32x32x16_bf16 a[16:31], v[92:95], a[236:239], a[16:31]
    s_waitcnt lgkmcnt(15)
    v_mfma_f32_32x32x16_bf16 a[0:15], v[96:99], a[240:243], a[0:15]
    v_accvgpr_read_b32 v132, a116
    v_accvgpr_read_b32 v133, a117
    v_accvgpr_read_b32 v134, a118
    v_accvgpr_read_b32 v135, a119
    v_mfma_f32_32x32x16_bf16 a[16:31], v[100:103], a[240:243], a[16:31]
    v_accvgpr_read_b32 v136, a120
    v_accvgpr_read_b32 v137, a121
    v_accvgpr_read_b32 v138, a122
    v_mfma_f32_32x32x16_bf16 a[0:15], v[104:107], a[244:247], a[0:15]
    v_accvgpr_read_b32 v139, a123
    v_accvgpr_read_b32 v140, a124
    v_accvgpr_read_b32 v141, a125
    v_accvgpr_read_b32 v142, a126
    v_mfma_f32_32x32x16_bf16 a[16:31], v[108:111], a[244:247], a[16:31]
    v_accvgpr_read_b32 v143, a127
    v_accvgpr_read_b32 v112, a96
    v_accvgpr_read_b32 v113, a97
    v_mfma_f32_32x32x16_bf16 a[32:47], v[160:163], a[248:251], a[32:47]
    v_accvgpr_read_b32 v114, a98
    v_accvgpr_read_b32 v115, a99
    v_accvgpr_read_b32 v116, a100
    v_accvgpr_read_b32 v117, a101
    v_mfma_f32_32x32x16_bf16 a[48:63], v[164:167], a[248:251], a[48:63]
    ds_write_b128 v6, a[0:3] offset:0
    v_accvgpr_read_b32 v118, a102
    v_mfma_f32_32x32x16_bf16 a[32:47], v[168:171], a[252:255], a[32:47]
    ds_write_b128 v6, a[4:7] offset:1024
    v_accvgpr_read_b32 v119, a103
    v_mfma_f32_32x32x16_bf16 a[48:63], v[172:175], a[252:255], a[48:63]
    v_mfma_f32_32x32x16_bf16 a[32:47], v[176:179], a[128:131], a[32:47]
    ds_write_b128 v6, a[8:11] offset:2048
    v_lshlrev_b32 v144, 16, v184
    v_and_b32 v228, s90, v184
    v_mfma_f32_32x32x16_bf16 a[48:63], v[180:183], a[128:131], a[48:63]
    ds_write_b128 v6, a[12:15] offset:3072
    v_lshlrev_b32 v145, 16, v188
    v_and_b32 v229, s90, v188
    s_waitcnt lgkmcnt(15)
    v_mfma_f32_32x32x16_bf16 a[32:47], v[88:91], a[132:135], a[32:47]
    v_lshlrev_b32 v146, 16, v192
    v_and_b32 v230, s90, v192
    v_lshlrev_b32 v147, 16, v196
    v_and_b32 v231, s90, v196
    v_lshlrev_b32 v148, 16, v185
    v_mfma_f32_32x32x16_bf16 a[48:63], v[92:95], a[132:135], a[48:63]
    ds_write_b128 v6, a[16:19] offset:4096
    v_and_b32 v232, s90, v185
    v_lshlrev_b32 v149, 16, v189
    v_mfma_f32_32x32x16_bf16 a[32:47], v[96:99], a[136:139], a[32:47]
    ds_write_b128 v6, a[20:23] offset:5120
    v_and_b32 v233, s90, v189
    v_lshlrev_b32 v150, 16, v193
    v_and_b32 v234, s90, v193
    v_mfma_f32_32x32x16_bf16 a[48:63], v[100:103], a[136:139], a[48:63]
    v_lshlrev_b32 v151, 16, v197
    v_and_b32 v235, s90, v197
    v_lshlrev_b32 v152, 16, v186
    v_and_b32 v236, s90, v186
    v_mfma_f32_32x32x16_bf16 a[32:47], v[104:107], a[140:143], a[32:47]
    ds_write_b128 v6, a[24:27] offset:6144
    v_lshlrev_b32 v153, 16, v190
    v_mfma_f32_32x32x16_bf16 a[48:63], v[108:111], a[140:143], a[48:63]
    ds_write_b128 v6, a[28:31] offset:7168
    v_mfma_f32_32x32x16_bf16 a[64:79], v[160:163], a[144:147], a[64:79]
    v_mfma_f32_32x32x16_bf16 a[80:95], v[164:167], a[144:147], a[80:95]
    ds_write_b128 v8, a[32:35] offset:0
    s_waitcnt lgkmcnt(15)
    v_mfma_f32_32x32x16_bf16 a[64:79], v[168:171], a[148:151], a[64:79]
    s_waitcnt lgkmcnt(1)
    s_barrier
    ds_write_b128 v8, a[36:39] offset:1024
    ds_read_b128 v[16:19], v7 offset:0
    ds_read_b128 v[20:23], v7 offset:1024
    v_mfma_f32_32x32x16_bf16 a[80:95], v[172:175], a[148:151], a[80:95]
    ds_read_b128 v[24:27], v7 offset:2048
    v_mfma_f32_32x32x16_bf16 a[64:79], v[176:179], a[152:155], a[64:79]
    ds_write_b128 v8, a[40:43] offset:2048
    ds_read_b128 v[28:31], v7 offset:3072
    v_mfma_f32_32x32x16_bf16 a[80:95], v[180:183], a[152:155], a[80:95]
    ds_write_b128 v8, a[44:47] offset:3072
    s_waitcnt lgkmcnt(5)
    v_pk_add_f32 v[112:113], v[112:113], v[16:17]
    v_pk_add_f32 v[114:115], v[114:115], v[18:19]
    s_waitcnt lgkmcnt(4)
    v_pk_add_f32 v[116:117], v[116:117], v[20:21]
    v_pk_add_f32 v[118:119], v[118:119], v[22:23]
    ds_read_b128 v[32:35], v7 offset:4096
    ds_read_b128 v[36:39], v7 offset:5120
    v_mfma_f32_32x32x16_bf16 a[64:79], v[88:91], a[156:159], a[64:79]
    s_waitcnt lgkmcnt(5)
    v_pk_add_f32 v[120:121], v[120:121], v[24:25]
    v_pk_add_f32 v[122:123], v[122:123], v[26:27]
    ds_read_b128 v[40:43], v7 offset:6144
    v_mfma_f32_32x32x16_bf16 a[80:95], v[92:95], a[156:159], a[80:95]
    ds_write_b128 v8, a[48:51] offset:4096
    s_waitcnt lgkmcnt(5)
    v_pk_add_f32 v[124:125], v[124:125], v[28:29]
    v_pk_add_f32 v[126:127], v[126:127], v[30:31]
    ds_read_b128 v[44:47], v7 offset:7168
    v_mfma_f32_32x32x16_bf16 a[64:79], v[96:99], a[160:163], a[64:79]
    ds_write_b128 v8, a[52:55] offset:5120
    s_waitcnt lgkmcnt(5)
    v_pk_add_f32 v[128:129], v[128:129], v[32:33]
    v_pk_add_f32 v[130:131], v[130:131], v[34:35]
    s_waitcnt lgkmcnt(4)
    v_pk_add_f32 v[132:133], v[132:133], v[36:37]
    v_pk_add_f32 v[134:135], v[134:135], v[38:39]
    v_mfma_f32_32x32x16_bf16 a[80:95], v[100:103], a[160:163], a[80:95]
    s_waitcnt lgkmcnt(3)
    v_pk_add_f32 v[136:137], v[136:137], v[40:41]
    v_pk_add_f32 v[138:139], v[138:139], v[42:43]
    v_and_b32 v237, s90, v190
    v_mfma_f32_32x32x16_bf16 a[64:79], v[104:107], a[164:167], a[64:79]
    ds_write_b128 v8, a[56:59] offset:6144
    s_waitcnt lgkmcnt(2)
    v_pk_add_f32 v[140:141], v[140:141], v[44:45]
    v_pk_add_f32 v[142:143], v[142:143], v[46:47]
    v_mfma_f32_32x32x16_bf16 a[80:95], v[108:111], a[164:167], a[80:95]
    ds_write_b128 v8, a[60:63] offset:7168
    v_lshlrev_b32 v154, 16, v194
    v_mfma_f32_32x32x16_bf16 v[112:127], v[160:163], a[168:171], v[112:127]
    v_and_b32 v238, s90, v194
    v_lshlrev_b32 v155, 16, v198
    v_and_b32 v239, s90, v198
    v_lshlrev_b32 v156, 16, v187
    v_mfma_f32_32x32x16_bf16 v[128:143], v[164:167], a[168:171], v[128:143]
    ds_write_b128 v9, a[64:67] offset:0
    v_mfma_f32_32x32x16_bf16 v[112:127], v[168:171], a[172:175], v[112:127]
    s_waitcnt lgkmcnt(1)
    s_barrier
    ds_write_b128 v9, a[68:71] offset:1024
    ds_read_b128 v[48:51], v7 offset:8192
    ds_read_b128 v[52:55], v7 offset:9216
    v_mfma_f32_32x32x16_bf16 v[128:143], v[172:175], a[172:175], v[128:143]
    ds_read_b128 v[56:59], v7 offset:10240
    v_mfma_f32_32x32x16_bf16 v[112:127], v[176:179], a[176:179], v[112:127]
    ds_write_b128 v9, a[72:75] offset:2048
    ds_read_b128 v[60:63], v7 offset:11264
    v_and_b32 v240, s90, v187
    v_mfma_f32_32x32x16_bf16 v[128:143], v[180:183], a[176:179], v[128:143]
    ds_write_b128 v9, a[76:79] offset:3072
    ds_read_b128 v[64:67], v7 offset:12288
    ds_read_b128 v[68:71], v7 offset:13312
    v_mfma_f32_32x32x16_bf16 v[112:127], v[88:91], a[180:183], v[112:127]
    ds_read_b128 v[72:75], v7 offset:14336
    v_lshlrev_b32 v157, 16, v191
    v_and_b32 v241, s90, v191
    v_lshlrev_b32 v158, 16, v195
    v_mfma_f32_32x32x16_bf16 v[128:143], v[92:95], a[180:183], v[128:143]
    ds_write_b128 v9, a[80:83] offset:4096
    ds_read_b128 v[76:79], v7 offset:15360
    v_mfma_f32_32x32x16_bf16 v[112:127], v[96:99], a[184:187], v[112:127]
    ds_write_b128 v9, a[84:87] offset:5120
    v_and_b32 v242, s90, v195
    v_lshlrev_b32 v159, 16, v199
    v_mfma_f32_32x32x16_bf16 v[128:143], v[100:103], a[184:187], v[128:143]
    v_and_b32 v243, s90, v199
    v_mfma_f32_32x32x16_bf16 v[112:127], v[104:107], a[188:191], v[112:127]
    ds_write_b128 v9, a[88:91] offset:6144
    v_mfma_f32_32x32x16_bf16 v[128:143], v[108:111], a[188:191], v[128:143]
    ds_write_b128 v9, a[92:95] offset:7168
    s_waitcnt lgkmcnt(0)
    s_barrier
    ds_read_b128 v[16:19], v7 offset:16384
    ds_read_b128 v[20:23], v7 offset:17408
    ds_read_b128 v[24:27], v7 offset:18432
    ds_read_b128 v[28:31], v7 offset:19456
    ds_read_b128 v[32:35], v7 offset:20480
    ds_read_b128 v[36:39], v7 offset:21504
    ds_read_b128 v[40:43], v7 offset:22528
    ds_read_b128 v[44:47], v7 offset:23552
    s_nop 3
    v_pk_add_f32 v[112:113], v[112:113], v[48:49]
    v_pk_add_f32 v[114:115], v[114:115], v[50:51]
    v_pk_add_f32 v[116:117], v[116:117], v[52:53]
    v_pk_add_f32 v[118:119], v[118:119], v[54:55]
    v_pk_add_f32 v[120:121], v[120:121], v[56:57]
    v_pk_add_f32 v[122:123], v[122:123], v[58:59]
    v_pk_add_f32 v[124:125], v[124:125], v[60:61]
    v_pk_add_f32 v[126:127], v[126:127], v[62:63]
    v_pk_add_f32 v[128:129], v[128:129], v[64:65]
    v_pk_add_f32 v[130:131], v[130:131], v[66:67]
    v_pk_add_f32 v[132:133], v[132:133], v[68:69]
    v_pk_add_f32 v[134:135], v[134:135], v[70:71]
    v_pk_add_f32 v[136:137], v[136:137], v[72:73]
    v_pk_add_f32 v[138:139], v[138:139], v[74:75]
    v_pk_add_f32 v[140:141], v[140:141], v[76:77]
    v_pk_add_f32 v[142:143], v[142:143], v[78:79]
    s_waitcnt lgkmcnt(7)
    v_pk_add_f32 v[112:113], v[112:113], v[16:17]
    v_pk_add_f32 v[114:115], v[114:115], v[18:19]
    s_waitcnt lgkmcnt(6)
    v_pk_add_f32 v[116:117], v[116:117], v[20:21]
    v_pk_add_f32 v[118:119], v[118:119], v[22:23]
    s_waitcnt lgkmcnt(5)
    v_pk_add_f32 v[120:121], v[120:121], v[24:25]
    v_pk_add_f32 v[122:123], v[122:123], v[26:27]
    s_waitcnt lgkmcnt(4)
    v_pk_add_f32 v[124:125], v[124:125], v[28:29]
    v_pk_add_f32 v[126:127], v[126:127], v[30:31]
    s_waitcnt lgkmcnt(3)
    v_pk_add_f32 v[128:129], v[128:129], v[32:33]
    v_pk_add_f32 v[130:131], v[130:131], v[34:35]
    s_waitcnt lgkmcnt(2)
    v_pk_add_f32 v[132:133], v[132:133], v[36:37]
    v_pk_add_f32 v[134:135], v[134:135], v[38:39]
    s_waitcnt lgkmcnt(1)
    v_pk_add_f32 v[136:137], v[136:137], v[40:41]
    v_pk_add_f32 v[138:139], v[138:139], v[42:43]
    s_waitcnt lgkmcnt(0)
    v_pk_add_f32 v[140:141], v[140:141], v[44:45]
    v_pk_add_f32 v[142:143], v[142:143], v[46:47]
    v_cvt_pk_bf16_f32 v112, 0, v112
    v_cvt_pk_bf16_f32 v113, 0, v113
    v_cvt_pk_bf16_f32 v114, 0, v114
    v_cvt_pk_bf16_f32 v115, 0, v115
    v_cvt_pk_bf16_f32 v116, 0, v116
    v_cvt_pk_bf16_f32 v117, 0, v117
    v_cvt_pk_bf16_f32 v118, 0, v118
    v_cvt_pk_bf16_f32 v119, 0, v119
    v_cvt_pk_bf16_f32 v120, 0, v120
    v_cvt_pk_bf16_f32 v121, 0, v121
    v_cvt_pk_bf16_f32 v122, 0, v122
    v_cvt_pk_bf16_f32 v123, 0, v123
    v_cvt_pk_bf16_f32 v124, 0, v124
    v_cvt_pk_bf16_f32 v125, 0, v125
    v_cvt_pk_bf16_f32 v126, 0, v126
    v_cvt_pk_bf16_f32 v127, 0, v127
    v_cvt_pk_bf16_f32 v128, 0, v128
    v_cvt_pk_bf16_f32 v129, 0, v129
    v_cvt_pk_bf16_f32 v130, 0, v130
    v_cvt_pk_bf16_f32 v131, 0, v131
    v_cvt_pk_bf16_f32 v132, 0, v132
    v_cvt_pk_bf16_f32 v133, 0, v133
    v_cvt_pk_bf16_f32 v134, 0, v134
    v_cvt_pk_bf16_f32 v135, 0, v135
    v_cvt_pk_bf16_f32 v136, 0, v136
    v_cvt_pk_bf16_f32 v137, 0, v137
    v_cvt_pk_bf16_f32 v138, 0, v138
    v_cvt_pk_bf16_f32 v139, 0, v139
    v_cvt_pk_bf16_f32 v140, 0, v140
    v_cvt_pk_bf16_f32 v141, 0, v141
    v_cvt_pk_bf16_f32 v142, 0, v142
    v_cvt_pk_bf16_f32 v143, 0, v143
    v_pk_add_f32 v[112:113], v[112:113], v[144:145]
    v_pk_add_f32 v[114:115], v[114:115], v[146:147]
    v_pk_add_f32 v[116:117], v[116:117], v[148:149]
    v_pk_add_f32 v[118:119], v[118:119], v[150:151]
    v_pk_add_f32 v[120:121], v[120:121], v[152:153]
    v_pk_add_f32 v[122:123], v[122:123], v[154:155]
    v_pk_add_f32 v[124:125], v[124:125], v[156:157]
    v_pk_add_f32 v[126:127], v[126:127], v[158:159]
    v_pk_add_f32 v[128:129], v[128:129], v[228:229]
    v_pk_add_f32 v[130:131], v[130:131], v[230:231]
    v_pk_add_f32 v[132:133], v[132:133], v[232:233]
    v_pk_add_f32 v[134:135], v[134:135], v[234:235]
    v_pk_add_f32 v[136:137], v[136:137], v[236:237]
    v_pk_add_f32 v[138:139], v[138:139], v[238:239]
    v_pk_add_f32 v[140:141], v[140:141], v[240:241]
    v_pk_add_f32 v[142:143], v[142:143], v[242:243]
    v_cvt_pk_bf16_f32 v112, v112, v128
    v_cvt_pk_bf16_f32 v113, v113, v129
    v_cvt_pk_bf16_f32 v114, v114, v130
    v_cvt_pk_bf16_f32 v115, v115, v131
    v_cvt_pk_bf16_f32 v116, v116, v132
    v_cvt_pk_bf16_f32 v117, v117, v133
    v_cvt_pk_bf16_f32 v118, v118, v134
    v_cvt_pk_bf16_f32 v119, v119, v135
    v_cvt_pk_bf16_f32 v120, v120, v136
    v_cvt_pk_bf16_f32 v121, v121, v137
    v_cvt_pk_bf16_f32 v122, v122, v138
    v_cvt_pk_bf16_f32 v123, v123, v139
    v_cvt_pk_bf16_f32 v124, v124, v140
    v_cvt_pk_bf16_f32 v125, v125, v141
    v_cvt_pk_bf16_f32 v126, v126, v142
    v_cvt_pk_bf16_f32 v127, v127, v143
    v_pk_max_i16 v112, v112, 0
    v_pk_max_i16 v113, v113, 0
    v_pk_max_i16 v114, v114, 0
    v_pk_max_i16 v115, v115, 0
    v_pk_max_i16 v116, v116, 0
    v_pk_max_i16 v117, v117, 0
    v_pk_max_i16 v118, v118, 0
    v_pk_max_i16 v119, v119, 0
    v_pk_max_i16 v120, v120, 0
    v_pk_max_i16 v121, v121, 0
    v_pk_max_i16 v122, v122, 0
    v_pk_max_i16 v123, v123, 0
    v_pk_max_i16 v124, v124, 0
    v_pk_max_i16 v125, v125, 0
    v_pk_max_i16 v126, v126, 0
    v_pk_max_i16 v127, v127, 0
    v_mov_b32 v12, 0
    v_dot2_f32_bf16 v12, v112, v200, v12
    v_dot2_f32_bf16 v12, v113, v204, v12
    v_dot2_f32_bf16 v12, v114, v208, v12
    v_dot2_f32_bf16 v12, v115, v212, v12
    v_dot2_f32_bf16 v12, v116, v201, v12
    v_dot2_f32_bf16 v12, v117, v205, v12
    v_dot2_f32_bf16 v12, v118, v209, v12
    v_dot2_f32_bf16 v12, v119, v213, v12
    v_dot2_f32_bf16 v12, v120, v202, v12
    v_dot2_f32_bf16 v12, v121, v206, v12
    v_dot2_f32_bf16 v12, v122, v210, v12
    v_dot2_f32_bf16 v12, v123, v214, v12
    v_dot2_f32_bf16 v12, v124, v203, v12
    v_dot2_f32_bf16 v12, v125, v207, v12
    v_dot2_f32_bf16 v12, v126, v211, v12
    v_dot2_f32_bf16 v12, v127, v215, v12
    s_nop 2
    v_mov_b32 v13, v12
    s_nop 1
    v_permlane32_swap_b32 v13, v12
    v_add_f32 v12, v12, v13
    s_cmp_eq_u32 s65, 0
    v_min_u32 v12, -2, v12
    s_cbranch_scc1 L_final
    buffer_store_dword v12, v5, s[60:63], 0 offen sc1
    s_endpgm
L_final:
    v_lshrrev_b32 v13, 5, v1
    v_lshl_add_u32 v13, v13, 11, v5
    s_mov_b32 s84, 0
    s_waitcnt vmcnt(1)
L_cnt:
    v_readfirstlane_b32 s81, v224
    s_cmp_ge_u32 s81, 8
    s_cbranch_scc1 L_poll
    buffer_load_dword v224, v11, s[56:59], 0 offen sc1
    s_add_u32 s84, s84, 1
    s_cmp_gt_u32 s84, 200000
    s_waitcnt vmcnt(0)
    s_cbranch_scc0 L_cnt
L_poll:
    buffer_load_dword v16, v13, s[60:63], 0 offen offset:0 sc1
    buffer_load_dword v17, v13, s[60:63], 0 offen offset:512 sc1
    buffer_load_dword v18, v13, s[60:63], 0 offen offset:1024 sc1
    buffer_load_dword v19, v13, s[60:63], 0 offen offset:1536 sc1
    s_add_u32 s84, s84, 1
    v_and_b32 v14, 1, v4
    v_lshlrev_b32 v14, 4, v14
    v_alignbit_b32 v24, v217, v216, v14
    v_alignbit_b32 v25, v218, v217, v14
    v_alignbit_b32 v26, v219, v218, v14
    v_alignbit_b32 v27, v220, v219, v14
    v_alignbit_b32 v28, v221, v220, v14
    v_alignbit_b32 v29, v222, v221, v14
    v_alignbit_b32 v30, v222, v222, v14
    v_and_b32 v30, 0xffff, v30
    s_and_b32 s78, s78, 0xffff
    v_mov_b32 v15, 0
    v_dot2_f32_bf16 v15, v24, s72, v15
    v_dot2_f32_bf16 v15, v25, s73, v15
    v_dot2_f32_bf16 v15, v26, s74, v15
    v_dot2_f32_bf16 v15, v27, s75, v15
    v_dot2_f32_bf16 v15, v28, s76, v15
    v_dot2_f32_bf16 v15, v29, s77, v15
    v_dot2_f32_bf16 v15, v30, s78, v15
    s_lshl_b32 s82, s79, 16
    s_lshl_b32 s83, s80, 16
    s_nop 1
    v_cvt_pk_bf16_f32 v15, 0, v15
    v_add_f32 v15, s82, v15
    v_cvt_pk_bf16_f32 v15, 0, v15
    s_waitcnt vmcnt(0)
    s_mov_b32 exec_hi, 0
    v_mov_b32 v16, v12
    s_mov_b32 exec_hi, -1
    v_max_u32 v20, v16, v17
    v_max3_u32 v20, v20, v18, v19
    s_cmp_gt_u32 s84, 200000
    v_cmp_eq_u32 vcc, -1, v20
    s_cbranch_scc1 L_go
    s_cbranch_vccnz L_poll
L_go:
    v_add_f32 v16, v16, v17
    v_add_f32 v18, v18, v19
    v_add_f32 v16, v16, v18
    v_mov_b32 v17, v16
    s_nop 1
    v_permlane32_swap_b32 v17, v16
    v_add_f32 v16, v16, v17
    v_cvt_pk_bf16_f32 v16, 0, v16
    v_add_f32 v16, s83, v16
    v_cvt_pk_bf16_f32 v16, 0, v16
    v_add_f32 v16, v15, v16
    v_cvt_pk_bf16_f32 v16, 0, v16
    v_mul_f32 v16, 0xbfb8aa3b, v16
    v_exp_f32 v16, v16
    s_nop 0
    v_add_f32 v16, 1.0, v16
    v_rcp_f32 v16, v16
    s_lshl_b32 s82, s66, 2
    s_add_u32 s82, s82, s64
    s_lshl_b32 s82, s82, 6
    v_cvt_pk_bf16_f32 v16, v16, v16
    v_lshlrev_b32 v17, 1, v4
    s_mov_b32 exec_hi, 0
    buffer_store_short v16, v17, s[52:55], s82 offen
L_end:
    s_endpgm
    Lpfc_end:
.section .rodata,"a"
.p2align 6
.amdhsa_kernel standalone__deep_cross_wide_deep__recsys_kernel
  .amdhsa_next_free_vgpr 512
  .amdhsa_next_free_sgpr 102
  .amdhsa_accum_offset 256
  .amdhsa_group_segment_fixed_size 0
  .amdhsa_kernarg_size 96
  .amdhsa_user_sgpr_count 2
  .amdhsa_user_sgpr_kernarg_segment_ptr 1
  .amdhsa_system_sgpr_workgroup_id_x 1
.end_amdhsa_kernel
```
